```python
import torch

def _softmax(x, axis=-1):
    return torch.softmax(x, dim=axis)
def _gelu(x):
    return torch.nn.functional.gelu(x, approximate="tanh")
def _silu(x):
    return torch.nn.functional.silu(x)
def _sigmoid(x):
    return torch.sigmoid(x)
def _layernorm(x, axis=-1, eps=1e-5):
    m = x.mean(dim=axis, keepdim=True)
    v = x.var(dim=axis, keepdim=True, unbiased=False)
    return (x - m) / torch.sqrt(v + eps)
def _scatter_add(tgt, idx, src, axis=0):
    return tgt.clone().index_add_(axis, idx, src)
def _segment_sum(src, seg, n):
    out = torch.zeros((n,) + src.shape[1:], dtype=src.dtype)
    return out.index_add_(0, seg, src)
def _pad(x, pw):
    flat = tuple(v for pair in reversed(pw) for v in pair)
    return torch.nn.functional.pad(x, flat)

kernel_name = 'gated_mix__linear_attn_block__linear_attn_block__prompt'

def setup_inputs():

    _w = (lambda a: (lambda t: t.to(torch.bfloat16) if t.is_floating_point() else t)(torch.as_tensor(a)))
    def _A_setup():
        B, S, D = 1, 2048, 1024
        return {
            "x": _w((lambda *s: torch.randn(*s, dtype=torch.bfloat16) * 0.05)(B, S, D)),
            "wqkv": _w((lambda *s: torch.randn(*s, dtype=torch.bfloat16) * 0.8)(D, 3 * D)),
            "wo": _w((lambda *s: torch.randn(*s, dtype=torch.bfloat16) * 0.05)(D, D)),
        }
    _A_in = _A_setup()

    def _B_setup():
        B, S, D = 1, 2048, 1024
        return {
            "x": _w((lambda *s: torch.randn(*s, dtype=torch.bfloat16) * 0.05)(B, S, D)),
            "wqkv": _w((lambda *s: torch.randn(*s, dtype=torch.bfloat16) * 0.8)(D, 3 * D)),
            "wo": _w((lambda *s: torch.randn(*s, dtype=torch.bfloat16) * 0.05)(D, D)),
        }
    _B_in = _B_setup()

    return {
        "A_x": _A_in["x"],
        "A_wqkv": _A_in["wqkv"],
        "A_wo": _A_in["wo"],
        "B_x": _B_in["x"],
        "B_wqkv": _B_in["wqkv"],
        "B_wo": _B_in["wo"],
        "gate_w": _w((lambda *s: torch.randn(*s, dtype=torch.bfloat16) * 0.05)(1024) * 16.0),
    }

def reference(A_x, A_wqkv, A_wo, B_x, B_wqkv, B_wo, gate_w):
    def _A_ref(x, wqkv, wo):
        B, S, D = x.shape
        H = 32; Dh = D // H
        qkv = (lambda x, *d: x.permute(*d))((x @ wqkv).reshape(B, S, 3, H, Dh), 2, 0, 3, 1, 4)
        q, k, v = qkv[0], qkv[1], qkv[2]
        phi = lambda t: torch.where(t > 0, t + 1, torch.exp(t)) + 1e-6
        pq, pk = phi(q), phi(k)
        kv = torch.einsum("bhsd,bhse->bhde", pk, v)
        z = torch.einsum("bhsd->bhd", pk)
        num = torch.einsum("bhqd,bhde->bhqe", pq, kv)
        den = torch.einsum("bhqd,bhd->bhq", pq, z)[..., None] + 1e-6
        o = num / den
        return (lambda x, *d: x.permute(*d))(o, 0, 2, 1, 3).reshape(B, S, D) @ wo

    def _B_ref(x, wqkv, wo):
        B, S, D = x.shape
        H = 32; Dh = D // H
        qkv = (lambda x, *d: x.permute(*d))((x @ wqkv).reshape(B, S, 3, H, Dh), 2, 0, 3, 1, 4)
        q, k, v = qkv[0], qkv[1], qkv[2]
        phi = lambda t: torch.where(t > 0, t + 1, torch.exp(t)) + 1e-6
        pq, pk = phi(q), phi(k)
        kv = torch.einsum("bhsd,bhse->bhde", pk, v)
        z = torch.einsum("bhsd->bhd", pk)
        num = torch.einsum("bhqd,bhde->bhqe", pq, kv)
        den = torch.einsum("bhqd,bhd->bhq", pq, z)[..., None] + 1e-6
        o = num / den
        return (lambda x, *d: x.permute(*d))(o, 0, 2, 1, 3).reshape(B, S, D) @ wo

    x = A_x
    g = _sigmoid((x * gate_w).sum(-1, keepdims=True))
    a = _A_ref(x, A_wqkv, A_wo)
    b = _B_ref(x, B_wqkv, B_wo)
    return g * a + (1 - g) * b
```

```asm
; @launch grid=(256,1,1) block=(512,1,1) lds=163840
.amdgcn_target "amdgcn-amd-amdhsa--gfx950"
.text
.globl gated_mix__linear_attn_block__linear_attn_block__prompt_kernel
.p2align 8
.type gated_mix__linear_attn_block__linear_attn_block__prompt_kernel,@function
gated_mix__linear_attn_block__linear_attn_block__prompt_kernel:
    s_cmp_ge_u32 s2, 256
    s_cbranch_scc1 L_end
    s_load_dwordx4 s[4:7], s[0:1], 0
    s_load_dwordx2 s[80:81], s[0:1], 16
    s_load_dwordx4 s[8:11], s[0:1], 32
    s_load_dwordx4 s[84:87], s[0:1], 48
    s_load_dwordx4 s[12:15], s[0:1], 64

    s_getpc_b64 s[16:17]
L_cw_pc0:
    s_and_b32 s16, s16, 0xffffff00
    s_lshr_b32 s18, s2, 3
    s_lshl_b32 s18, s18, 10
    s_min_u32 s18, s18, (L_end - L_cw_pc0 - 1024) & 0xffffff80
    v_cmp_gt_u32 vcc, 64, v0
    v_lshlrev_b32 v4, 4, v0
    v_add_u32 v4, s18, v4
    s_cbranch_vccz L_nocw0
    global_load_dwordx4 v[8:11], v4, s[16:17]
L_nocw0:

    v_lshrrev_b32 v2, 6, v0
    v_and_b32 v1, 63, v0
    s_and_b32 s40, s2, 7
    v_readfirstlane_b32 s41, v2
    s_lshr_b32 s42, s2, 3

    s_and_b32 s43, s42, 3
    s_lshl_b32 s44, s40, 2
    s_add_u32 s44, s44, s43
    s_lshr_b32 s45, s42, 2
    s_lshr_b32 s43, s40, 1
    s_lshl_b32 s43, s43, 2
    s_lshr_b32 s88, s42, 3
    s_lshl_b32 s49, s88, 3
    s_add_u32 s88, s88, s43
    s_and_b32 s43, s40, 1
    s_lshl_b32 s43, s43, 3
    s_and_b32 s89, s42, 7
    s_lshl_b32 s3, s89, 2

    s_and_b32 s49, s49, 31
    s_add_u32 s89, s89, s43

    s_lshr_b32 s46, s44, 4
    s_and_b32 s47, s44, 15
    s_add_u32 s48, s40, s45
    s_lshl_b32 s48, s48, 1
    s_and_b32 s48, s48, 15

    s_cmp_lt_u32 s41, 4
    s_cbranch_scc1 L_cons
    s_cmp_eq_u32 s41, 5
    s_cbranch_scc1 L_up5
    s_cmp_eq_u32 s41, 6
    s_cbranch_scc1 L_up6
    s_cmp_eq_u32 s41, 7
    s_cbranch_scc1 L_up7

L_ld:
    s_setprio 3
    s_lshl_b32 s54, s48, 7

    v_lshrrev_b32 v3, 3, v1
    v_lshrrev_b32 v4, 4, v1
    v_and_b32 v5, 7, v1
    s_lshl_b32 s51, s45, 8
    v_add_u32 v3, s51, v3
    v_lshlrev_b32 v3, 11, v3
    v_xor_b32 v4, v4, v5
    v_lshlrev_b32 v4, 4, v4
    v_add_u32 v20, v3, v4
    v_xor_b32 v11, 64, v20
    v_add_u32 v21, 15360, v11
    v_add_u32 v22, 30720, v20
    v_add_u32 v23, 46080, v11

    s_waitcnt lgkmcnt(0)
    s_mov_b32 s20, s4
    s_mov_b32 s21, s5
    s_mov_b32 s22, 0x400000
    s_mov_b32 s23, 0x20000
    s_cmp_eq_u32 s46, 0
    s_cselect_b32 s24, s6, s8
    s_cselect_b32 s25, s7, s9
    s_mov_b32 s26, 0x600000
    s_mov_b32 s27, 0x20000
    s_mov_b32 s28, s14
    s_mov_b32 s29, s15
    s_mov_b32 s30, 0x10000000
    s_mov_b32 s31, 0x20000

    s_mov_b32 m0, 69632
    s_add_u32 s58, s54, 0
    buffer_load_dwordx4 v20, s[20:23], s58 offen offset:0 lds
    buffer_load_dwordx4 v21, s[20:23], s58 offen offset:1024 lds
    buffer_load_dwordx4 v22, s[20:23], s58 offen offset:2048 lds
    buffer_load_dwordx4 v23, s[20:23], s58 offen offset:3072 lds
    s_mov_b32 m0, 73728
    s_add_u32 s58, s54, 65536
    buffer_load_dwordx4 v20, s[20:23], s58 offen offset:0 lds
    buffer_load_dwordx4 v21, s[20:23], s58 offen offset:1024 lds
    buffer_load_dwordx4 v22, s[20:23], s58 offen offset:2048 lds
    buffer_load_dwordx4 v23, s[20:23], s58 offen offset:3072 lds
    s_mov_b32 m0, 77824
    s_add_u32 s58, s54, 131072
    buffer_load_dwordx4 v20, s[20:23], s58 offen offset:0 lds
    buffer_load_dwordx4 v21, s[20:23], s58 offen offset:1024 lds
    buffer_load_dwordx4 v22, s[20:23], s58 offen offset:2048 lds
    buffer_load_dwordx4 v23, s[20:23], s58 offen offset:3072 lds
    s_mov_b32 m0, 81920
    s_add_u32 s58, s54, 196608
    buffer_load_dwordx4 v20, s[20:23], s58 offen offset:0 lds
    buffer_load_dwordx4 v21, s[20:23], s58 offen offset:1024 lds
    buffer_load_dwordx4 v22, s[20:23], s58 offen offset:2048 lds
    buffer_load_dwordx4 v23, s[20:23], s58 offen offset:3072 lds
    s_mov_b32 m0, 86016
    s_add_u32 s58, s54, 262144
    buffer_load_dwordx4 v20, s[20:23], s58 offen offset:0 lds
    buffer_load_dwordx4 v21, s[20:23], s58 offen offset:1024 lds
    buffer_load_dwordx4 v22, s[20:23], s58 offen offset:2048 lds
    buffer_load_dwordx4 v23, s[20:23], s58 offen offset:3072 lds
    s_mov_b32 m0, 90112
    s_add_u32 s58, s54, 327680
    buffer_load_dwordx4 v20, s[20:23], s58 offen offset:0 lds
    buffer_load_dwordx4 v21, s[20:23], s58 offen offset:1024 lds
    buffer_load_dwordx4 v22, s[20:23], s58 offen offset:2048 lds
    buffer_load_dwordx4 v23, s[20:23], s58 offen offset:3072 lds
    s_mov_b32 m0, 94208
    s_add_u32 s58, s54, 393216
    buffer_load_dwordx4 v20, s[20:23], s58 offen offset:0 lds
    buffer_load_dwordx4 v21, s[20:23], s58 offen offset:1024 lds
    buffer_load_dwordx4 v22, s[20:23], s58 offen offset:2048 lds
    buffer_load_dwordx4 v23, s[20:23], s58 offen offset:3072 lds
    s_mov_b32 m0, 98304
    s_add_u32 s58, s54, 458752
    buffer_load_dwordx4 v20, s[20:23], s58 offen offset:0 lds
    buffer_load_dwordx4 v21, s[20:23], s58 offen offset:1024 lds
    buffer_load_dwordx4 v22, s[20:23], s58 offen offset:2048 lds
    buffer_load_dwordx4 v23, s[20:23], s58 offen offset:3072 lds
    s_branch L_ld2
L_up5:
    s_mul_i32 s55, s48, 393216

    v_lshrrev_b32 v3, 3, v1
    v_mul_u32_u24 v6, 6144, v3
    v_lshrrev_b32 v4, 4, v1
    v_and_b32 v7, 1, v4
    v_lshlrev_b32 v7, 2, v7
    v_and_b32 v5, 7, v1
    v_xor_b32 v7, v7, v5
    v_lshlrev_b32 v7, 4, v7
    s_lshl_b32 s51, s47, 7
    v_add3_u32 v24, v6, v7, s51
    v_xor_b32 v13, 32, v24
    v_add_u32 v25, 48128, v13
    v_add_u32 v26, 96256, v24
    v_add_u32 v27, 144384, v13

    s_waitcnt lgkmcnt(0)
    s_mov_b32 s20, s4
    s_mov_b32 s21, s5
    s_mov_b32 s22, 0x400000
    s_mov_b32 s23, 0x20000
    s_cmp_eq_u32 s46, 0
    s_cselect_b32 s24, s6, s8
    s_cselect_b32 s25, s7, s9
    s_mov_b32 s26, 0x600000
    s_mov_b32 s27, 0x20000
    s_mov_b32 s28, s14
    s_mov_b32 s29, s15
    s_mov_b32 s30, 0x10000000
    s_mov_b32 s31, 0x20000

    s_mov_b32 m0, 102400
    s_add_u32 s58, s55, 0
    buffer_load_dwordx4 v24, s[24:27], s58 offen offset:0 lds
    buffer_load_dwordx4 v25, s[24:27], s58 offen offset:1024 lds
    buffer_load_dwordx4 v26, s[24:27], s58 offen offset:2048 lds
    buffer_load_dwordx4 v27, s[24:27], s58 offen offset:3072 lds
    s_mov_b32 m0, 106496
    s_add_u32 s58, s55, 2048
    buffer_load_dwordx4 v24, s[24:27], s58 offen offset:0 lds
    buffer_load_dwordx4 v25, s[24:27], s58 offen offset:1024 lds
    buffer_load_dwordx4 v26, s[24:27], s58 offen offset:2048 lds
    buffer_load_dwordx4 v27, s[24:27], s58 offen offset:3072 lds
    s_mov_b32 m0, 110592
    s_add_u32 s58, s55, 4096
    buffer_load_dwordx4 v24, s[24:27], s58 offen offset:0 lds
    buffer_load_dwordx4 v25, s[24:27], s58 offen offset:1024 lds
    buffer_load_dwordx4 v26, s[24:27], s58 offen offset:2048 lds
    buffer_load_dwordx4 v27, s[24:27], s58 offen offset:3072 lds
    s_add_u32 s55, s55, 196608
    s_cmp_ge_u32 s55, 6291456
    s_cselect_b32 s55, 0, s55

    v_and_b32 v3, 3, v1
    v_lshlrev_b32 v15, 8, v3
    s_barrier

    s_mov_b32 m0, 114688
    s_add_u32 s58, s55, 0
    buffer_load_dwordx4 v24, s[24:27], s58 offen offset:0 lds
    buffer_load_dwordx4 v25, s[24:27], s58 offen offset:1024 lds
    buffer_load_dwordx4 v26, s[24:27], s58 offen offset:2048 lds
    buffer_load_dwordx4 v27, s[24:27], s58 offen offset:3072 lds
    s_mov_b32 m0, 118784
    s_add_u32 s58, s55, 2048
    buffer_load_dwordx4 v24, s[24:27], s58 offen offset:0 lds
    buffer_load_dwordx4 v25, s[24:27], s58 offen offset:1024 lds
    buffer_load_dwordx4 v26, s[24:27], s58 offen offset:2048 lds
    buffer_load_dwordx4 v27, s[24:27], s58 offen offset:3072 lds
    s_mov_b32 m0, 122880
    s_add_u32 s58, s55, 4096
    buffer_load_dwordx4 v24, s[24:27], s58 offen offset:0 lds
    buffer_load_dwordx4 v25, s[24:27], s58 offen offset:1024 lds
    buffer_load_dwordx4 v26, s[24:27], s58 offen offset:2048 lds
    buffer_load_dwordx4 v27, s[24:27], s58 offen offset:3072 lds
    s_add_u32 s55, s55, 196608
    s_cmp_ge_u32 s55, 6291456
    s_cselect_b32 s55, 0, s55

    s_waitcnt vmcnt(12)
    v_mov_b32 v14, 3
    ds_write_b32 v15, v14 offset:4
    s_mov_b32 m0, 126976
    s_add_u32 s58, s55, 0
    buffer_load_dwordx4 v24, s[24:27], s58 offen offset:0 lds
    buffer_load_dwordx4 v25, s[24:27], s58 offen offset:1024 lds
    buffer_load_dwordx4 v26, s[24:27], s58 offen offset:2048 lds
    buffer_load_dwordx4 v27, s[24:27], s58 offen offset:3072 lds
    s_mov_b32 m0, 131072
    s_add_u32 s58, s55, 2048
    buffer_load_dwordx4 v24, s[24:27], s58 offen offset:0 lds
    buffer_load_dwordx4 v25, s[24:27], s58 offen offset:1024 lds
    buffer_load_dwordx4 v26, s[24:27], s58 offen offset:2048 lds
    buffer_load_dwordx4 v27, s[24:27], s58 offen offset:3072 lds
    s_mov_b32 m0, 135168
    s_add_u32 s58, s55, 4096
    buffer_load_dwordx4 v24, s[24:27], s58 offen offset:0 lds
    buffer_load_dwordx4 v25, s[24:27], s58 offen offset:1024 lds
    buffer_load_dwordx4 v26, s[24:27], s58 offen offset:2048 lds
    buffer_load_dwordx4 v27, s[24:27], s58 offen offset:3072 lds
    s_add_u32 s55, s55, 196608
    s_cmp_ge_u32 s55, 6291456
    s_cselect_b32 s55, 0, s55

    s_waitcnt vmcnt(12)
    v_mov_b32 v14, 4
    ds_write_b32 v15, v14 offset:4
    s_waitcnt vmcnt(0)
    v_mov_b32 v14, 1000
    ds_write_b32 v15, v14 offset:4
    s_branch L_up_s
L_up6:
    s_lshl_b32 s54, s48, 7
    s_add_u32 s54, s54, 128

    v_lshrrev_b32 v3, 3, v1
    v_lshrrev_b32 v4, 4, v1
    v_and_b32 v5, 7, v1
    s_lshl_b32 s51, s45, 8
    v_add_u32 v3, s51, v3
    v_lshlrev_b32 v3, 11, v3
    v_xor_b32 v4, v4, v5
    v_lshlrev_b32 v4, 4, v4
    v_add_u32 v20, v3, v4
    v_xor_b32 v11, 64, v20
    v_add_u32 v21, 15360, v11
    v_add_u32 v22, 30720, v20
    v_add_u32 v23, 46080, v11

    s_waitcnt lgkmcnt(0)
    s_mov_b32 s20, s4
    s_mov_b32 s21, s5
    s_mov_b32 s22, 0x400000
    s_mov_b32 s23, 0x20000
    s_cmp_eq_u32 s46, 0
    s_cselect_b32 s24, s6, s8
    s_cselect_b32 s25, s7, s9
    s_mov_b32 s26, 0x600000
    s_mov_b32 s27, 0x20000
    s_mov_b32 s28, s14
    s_mov_b32 s29, s15
    s_mov_b32 s30, 0x10000000
    s_mov_b32 s31, 0x20000

    v_and_b32 v3, 3, v1
    v_lshlrev_b32 v15, 8, v3
    s_barrier

    v_mov_b32 v14, 4
    ds_write_b32 v15, v14 offset:8
    s_mov_b32 m0, 4096
    s_add_u32 s58, s54, 0
    buffer_load_dwordx4 v20, s[20:23], s58 offen offset:0 lds
    buffer_load_dwordx4 v21, s[20:23], s58 offen offset:1024 lds
    buffer_load_dwordx4 v22, s[20:23], s58 offen offset:2048 lds
    buffer_load_dwordx4 v23, s[20:23], s58 offen offset:3072 lds
    s_mov_b32 m0, 8192
    s_add_u32 s58, s54, 65536
    buffer_load_dwordx4 v20, s[20:23], s58 offen offset:0 lds
    buffer_load_dwordx4 v21, s[20:23], s58 offen offset:1024 lds
    buffer_load_dwordx4 v22, s[20:23], s58 offen offset:2048 lds
    buffer_load_dwordx4 v23, s[20:23], s58 offen offset:3072 lds
    s_mov_b32 m0, 12288
    s_add_u32 s58, s54, 131072
    buffer_load_dwordx4 v20, s[20:23], s58 offen offset:0 lds
    buffer_load_dwordx4 v21, s[20:23], s58 offen offset:1024 lds
    buffer_load_dwordx4 v22, s[20:23], s58 offen offset:2048 lds
    buffer_load_dwordx4 v23, s[20:23], s58 offen offset:3072 lds
    s_mov_b32 m0, 16384
    s_add_u32 s58, s54, 196608
    buffer_load_dwordx4 v20, s[20:23], s58 offen offset:0 lds
    buffer_load_dwordx4 v21, s[20:23], s58 offen offset:1024 lds
    buffer_load_dwordx4 v22, s[20:23], s58 offen offset:2048 lds
    buffer_load_dwordx4 v23, s[20:23], s58 offen offset:3072 lds
    s_mov_b32 m0, 20480
    s_add_u32 s58, s54, 262144
    buffer_load_dwordx4 v20, s[20:23], s58 offen offset:0 lds
    buffer_load_dwordx4 v21, s[20:23], s58 offen offset:1024 lds
    buffer_load_dwordx4 v22, s[20:23], s58 offen offset:2048 lds
    buffer_load_dwordx4 v23, s[20:23], s58 offen offset:3072 lds
    s_mov_b32 m0, 24576
    s_add_u32 s58, s54, 327680
    buffer_load_dwordx4 v20, s[20:23], s58 offen offset:0 lds
    buffer_load_dwordx4 v21, s[20:23], s58 offen offset:1024 lds
    buffer_load_dwordx4 v22, s[20:23], s58 offen offset:2048 lds
    buffer_load_dwordx4 v23, s[20:23], s58 offen offset:3072 lds
    s_mov_b32 m0, 28672
    s_add_u32 s58, s54, 393216
    buffer_load_dwordx4 v20, s[20:23], s58 offen offset:0 lds
    buffer_load_dwordx4 v21, s[20:23], s58 offen offset:1024 lds
    buffer_load_dwordx4 v22, s[20:23], s58 offen offset:2048 lds
    buffer_load_dwordx4 v23, s[20:23], s58 offen offset:3072 lds
    s_mov_b32 m0, 32768
    s_add_u32 s58, s54, 458752
    buffer_load_dwordx4 v20, s[20:23], s58 offen offset:0 lds
    buffer_load_dwordx4 v21, s[20:23], s58 offen offset:1024 lds
    buffer_load_dwordx4 v22, s[20:23], s58 offen offset:2048 lds
    buffer_load_dwordx4 v23, s[20:23], s58 offen offset:3072 lds
    s_waitcnt vmcnt(20)
    v_mov_b32 v14, 1
    ds_write_b32 v15, v14 offset:12
    s_waitcnt vmcnt(0)
    v_mov_b32 v14, 1000
    ds_write_b32 v15, v14 offset:8
    s_branch L_up_s
L_up7:
    s_waitcnt lgkmcnt(0)
    s_mov_b32 s20, s4
    s_mov_b32 s21, s5
    s_mov_b32 s22, 0x400000
    s_mov_b32 s23, 0x20000
    s_cmp_eq_u32 s46, 0
    s_cselect_b32 s24, s6, s8
    s_cselect_b32 s25, s7, s9
    s_mov_b32 s26, 0x600000
    s_mov_b32 s27, 0x20000
    s_mov_b32 s28, s14
    s_mov_b32 s29, s15
    s_mov_b32 s30, 0x10000000
    s_mov_b32 s31, 0x20000

    s_cmp_eq_u32 s2, 0
    s_cbranch_scc0 L_up_nn
    s_memrealtime s[60:61]
    v_mov_b32 v16, 0
    s_waitcnt lgkmcnt(0)
    s_or_b32 s60, s60, 1
    v_mov_b32 v17, s60
    s_mov_b64 exec, 1
    global_store_dword v16, v17, s[12:13] sc0 sc1
    s_mov_b64 exec, -1
L_up_nn:
    s_barrier
    s_branch L_up_s

L_ld2:
    s_barrier
    v_lshrrev_b32 v3, 3, v1
    v_mul_u32_u24 v6, 6144, v3
    v_lshrrev_b32 v4, 4, v1
    v_and_b32 v7, 1, v4
    v_lshlrev_b32 v7, 2, v7
    v_and_b32 v5, 7, v1
    v_xor_b32 v7, v7, v5
    v_lshlrev_b32 v7, 4, v7
    s_lshl_b32 s51, s47, 7
    v_add3_u32 v24, v6, v7, s51
    v_xor_b32 v13, 32, v24
    v_add_u32 v25, 48128, v13
    v_add_u32 v26, 96256, v24
    v_add_u32 v27, 144384, v13

    s_sub_u32 s50, s41, 4
    v_lshrrev_b32 v100, 3, v1
    v_lshlrev_b32 v100, 11, v100
    v_bfe_u32 v101, v1, 4, 2
    v_lshlrev_b32 v101, 1, v101
    v_and_b32 v102, 7, v1
    v_xor_b32 v101, v101, v102
    v_lshlrev_b32 v101, 4, v101
    s_lshl_b32 s76, s89, 7
    v_add3_u32 v116, v100, v101, s76
    v_add_u32 v117, 16384, v116
    v_add_u32 v118, 32768, v116
    v_add_u32 v119, 49152, v116
    s_mov_b32 s32, s80
    s_mov_b32 s33, s81
    s_mov_b32 s34, 0x200000
    s_mov_b32 s35, 0x20000
    s_mov_b32 s36, s10
    s_mov_b32 s37, s11
    s_mov_b32 s38, 0x200000
    s_mov_b32 s39, 0x20000
    s_lshl_b32 s74, s50, 2
    s_add_u32 s74, s74, s49
    s_add_u32 s75, s74, 16
    s_and_b32 s74, s74, 31
    s_lshl_b32 s74, s74, 16

    s_and_b32 s75, s75, 31
    s_lshl_b32 s75, s75, 16
    v_lshlrev_b32 v2, 4, v1
    s_lshl_b32 s76, s50, 15
    s_add_u32 s76, s76, 32768
    v_add_u32 v120, s76, v2
    s_and_b32 s77, s50, 1
    s_lshr_b32 s78, s50, 1
    s_lshl_b32 s76, s44, 1
    s_add_u32 s76, s76, s77
    s_lshl_b32 s76, s76, 1
    s_add_u32 s76, s76, s78
    s_mul_i32 s69, s76, 24576
    s_add_u32 s69, s69, 8388608
    s_mul_i32 s68, s45, 3072
    s_add_u32 s68, s68, s69
    s_mul_i32 s70, s77, 5120
    s_add_u32 s70, s70, 4096
    s_lshl_b32 s76, s78, 11
    s_add_u32 s76, s76, s70
    v_add_u32 v121, s76, v2
    s_lshl_b32 s76, s78, 8
    s_add_u32 s76, s76, s70
    s_add_u32 s76, s76, 4096
    v_lshlrev_b32 v100, 2, v1
    v_add_u32 v122, s76, v100
    s_lshl_b32 s76, s77, 8
    v_mov_b32 v123, s76
    s_mul_i32 s76, s77, 3072
    s_lshl_b32 s70, s78, 3
    s_add_u32 s76, s76, s70
    s_add_u32 s76, s76, 24576
    v_add_u32 v124, s76, v2
    s_lshl_b32 s76, s50, 2
    v_mov_b32 v125, s76
    v_lshrrev_b32 v103, 5, v1
    v_lshlrev_b32 v103, 11, v103
    v_and_b32 v100, 31, v1
    v_lshlrev_b32 v100, 4, v100
    s_and_b32 s76, s40, 3
    s_lshl_b32 s76, s76, 9
    v_add3_u32 v103, v103, v100, s76
    s_and_b32 s95, s42, 7
    s_add_u32 s95, s95, 4
    s_mul_i32 s95, s95, 3
    s_add_u32 s95, s95, 2

    v_and_b32 v3, 3, v1
    v_lshlrev_b32 v16, 8, v3
    v_mov_b32 v14, 6
    s_add_u32 s54, s54, 256
    s_and_b32 s54, s54, 2047
    s_mov_b32 s52, 36864
    s_mov_b32 s53, 139264
    s_lshl_b32 s55, s48, 1
    s_add_u32 s55, s55, 3
    s_and_b32 s55, s55, 31
    s_mul_i32 s55, s55, 196608
    s_mov_b32 s56, 7
    s_mov_b32 s57, 0
    s_mov_b32 s60, 6
    s_waitcnt vmcnt(0)
    ds_write_b32 v16, v14 offset:0
    s_mov_b32 s66, 0
L_ld_h:
    ds_read_b32 v17, v16 offset:12
    s_waitcnt lgkmcnt(0)
    v_cmp_eq_u32 vcc, 0, v17
    s_add_u32 s66, s66, 1
    s_cbranch_vccz L_ld_hok
    s_cmp_lt_u32 s66, 1600000
    s_cbranch_scc1 L_ld_h
L_ld_hok:
    v_mov_b32 v17, 0

L_ld_loop:
    s_sub_i32 s59, s56, 9
    s_waitcnt lgkmcnt(0)
    v_cmp_gt_i32 vcc, s59, v17
    s_mov_b32 s66, 0
    s_cbranch_vccz L_ua_go

    ds_read_b32 v17, v16 offset:1024
    s_waitcnt lgkmcnt(0)
    v_cmp_gt_i32 vcc, s59, v17
    s_nop 0
    s_cbranch_vccz L_ua_go

    s_waitcnt vmcnt(0)
    s_sub_u32 s61, s56, 1
    s_max_u32 s60, s60, s61
    v_mov_b32 v14, s60
    ds_write_b32 v16, v14 offset:0

L_ua_spin:
    ds_read_b32 v17, v16 offset:1024
    s_waitcnt lgkmcnt(0)
    v_cmp_gt_i32 vcc, s59, v17
    s_add_u32 s66, s66, 1
    s_cbranch_vccz L_ua_go
    s_sleep 1
    s_cmp_lt_u32 s66, 1600000
    s_cbranch_scc1 L_ua_spin
L_ua_go:

    s_waitcnt vmcnt(24)
    s_add_u32 m0, s53, 0
    s_add_u32 s58, s55, 0
    buffer_load_dwordx4 v24, s[24:27], s58 offen offset:0  lds
    s_waitcnt vmcnt(24)
    buffer_load_dwordx4 v25, s[24:27], s58 offen offset:1024  lds
    s_waitcnt vmcnt(24)
    buffer_load_dwordx4 v26, s[24:27], s58 offen offset:2048  lds
    s_waitcnt vmcnt(24)
    buffer_load_dwordx4 v27, s[24:27], s58 offen offset:3072  lds
    s_waitcnt vmcnt(24)
    s_add_u32 m0, s53, 4096
    s_add_u32 s58, s55, 2048
    buffer_load_dwordx4 v24, s[24:27], s58 offen offset:0  lds
    s_waitcnt vmcnt(24)
    buffer_load_dwordx4 v25, s[24:27], s58 offen offset:1024  lds
    s_waitcnt vmcnt(24)
    buffer_load_dwordx4 v26, s[24:27], s58 offen offset:2048  lds
    s_waitcnt vmcnt(24)
    buffer_load_dwordx4 v27, s[24:27], s58 offen offset:3072  lds
    ds_read_b32 v17, v16 offset:1024
    s_waitcnt vmcnt(24)
    s_add_u32 m0, s53, 8192
    s_add_u32 s58, s55, 4096
    buffer_load_dwordx4 v24, s[24:27], s58 offen offset:0  lds
    s_waitcnt vmcnt(24)
    buffer_load_dwordx4 v25, s[24:27], s58 offen offset:1024  lds
    s_waitcnt vmcnt(24)
    buffer_load_dwordx4 v26, s[24:27], s58 offen offset:2048  lds
    s_waitcnt vmcnt(24)
    buffer_load_dwordx4 v27, s[24:27], s58 offen offset:3072  lds
    s_add_u32 s55, s55, 196608
    s_cmp_ge_u32 s55, 6291456
    s_cselect_b32 s55, 0, s55
    s_add_u32 s53, s53, 12288
    s_cmp_ge_u32 s53, 163840
    s_cselect_b32 s53, 102400, s53

    s_add_u32 s56, s56, 1
    s_sub_i32 s59, s56, 9
    s_waitcnt lgkmcnt(0)
    v_cmp_gt_i32 vcc, s59, v17
    s_mov_b32 s66, 0
    s_cbranch_vccz L_ub_go

    ds_read_b32 v17, v16 offset:1024
    s_waitcnt lgkmcnt(0)
    v_cmp_gt_i32 vcc, s59, v17
    s_nop 0
    s_cbranch_vccz L_ub_go

    s_waitcnt vmcnt(12)
    s_sub_u32 s61, s56, 2
    s_max_u32 s60, s60, s61
    v_mov_b32 v14, s60
    ds_write_b32 v16, v14 offset:0

    s_waitcnt vmcnt(0)
    s_sub_u32 s61, s56, 1
    s_max_u32 s60, s60, s61
    v_mov_b32 v14, s60
    ds_write_b32 v16, v14 offset:0

L_ub_spin:
    ds_read_b32 v17, v16 offset:1024
    s_waitcnt lgkmcnt(0)
    v_cmp_gt_i32 vcc, s59, v17
    s_add_u32 s66, s66, 1
    s_cbranch_vccz L_ub_go
    s_sleep 1
    s_cmp_lt_u32 s66, 1600000
    s_cbranch_scc1 L_ub_spin
L_ub_go:

    s_waitcnt vmcnt(24)
    s_add_u32 m0, s53, 0
    s_add_u32 s58, s55, 0
    buffer_load_dwordx4 v24, s[24:27], s58 offen offset:0  lds
    s_waitcnt vmcnt(24)
    buffer_load_dwordx4 v25, s[24:27], s58 offen offset:1024  lds
    s_waitcnt vmcnt(24)
    buffer_load_dwordx4 v26, s[24:27], s58 offen offset:2048  lds
    s_waitcnt vmcnt(24)
    buffer_load_dwordx4 v27, s[24:27], s58 offen offset:3072  lds
    s_waitcnt vmcnt(24)
    s_add_u32 m0, s53, 4096
    s_add_u32 s58, s55, 2048
    buffer_load_dwordx4 v24, s[24:27], s58 offen offset:0  lds
    s_waitcnt vmcnt(24)
    buffer_load_dwordx4 v25, s[24:27], s58 offen offset:1024  lds
    s_waitcnt vmcnt(24)
    buffer_load_dwordx4 v26, s[24:27], s58 offen offset:2048  lds
    s_waitcnt vmcnt(24)
    buffer_load_dwordx4 v27, s[24:27], s58 offen offset:3072  lds
    ds_read_b32 v17, v16 offset:1024
    s_waitcnt vmcnt(24)
    s_add_u32 m0, s53, 8192
    s_add_u32 s58, s55, 4096
    buffer_load_dwordx4 v24, s[24:27], s58 offen offset:0  lds
    s_waitcnt vmcnt(24)
    buffer_load_dwordx4 v25, s[24:27], s58 offen offset:1024  lds
    s_waitcnt vmcnt(24)
    buffer_load_dwordx4 v26, s[24:27], s58 offen offset:2048  lds
    s_waitcnt vmcnt(24)
    buffer_load_dwordx4 v27, s[24:27], s58 offen offset:3072  lds
    s_add_u32 s55, s55, 196608
    s_cmp_ge_u32 s55, 6291456
    s_cselect_b32 s55, 0, s55
    s_add_u32 s53, s53, 12288
    s_cmp_ge_u32 s53, 163840
    s_cselect_b32 s53, 102400, s53

    s_add_u32 s56, s56, 1
    s_sub_i32 s59, s56, 9
    s_waitcnt lgkmcnt(0)
    v_cmp_gt_i32 vcc, s59, v17
    s_mov_b32 s66, 0
    s_cbranch_vccz L_uc_go

    ds_read_b32 v17, v16 offset:1024
    s_waitcnt lgkmcnt(0)
    v_cmp_gt_i32 vcc, s59, v17
    s_nop 0
    s_cbranch_vccz L_uc_go

    s_waitcnt vmcnt(24)
    s_sub_u32 s61, s56, 3
    s_max_u32 s60, s60, s61
    v_mov_b32 v14, s60
    ds_write_b32 v16, v14 offset:0

    s_waitcnt vmcnt(12)
    s_sub_u32 s61, s56, 2
    s_max_u32 s60, s60, s61
    v_mov_b32 v14, s60
    ds_write_b32 v16, v14 offset:0

    s_waitcnt vmcnt(0)
    s_sub_u32 s61, s56, 1
    s_max_u32 s60, s60, s61
    v_mov_b32 v14, s60
    ds_write_b32 v16, v14 offset:0

L_uc_spin:
    ds_read_b32 v17, v16 offset:1024
    s_waitcnt lgkmcnt(0)
    v_cmp_gt_i32 vcc, s59, v17
    s_add_u32 s66, s66, 1
    s_cbranch_vccz L_uc_go
    s_sleep 1
    s_cmp_lt_u32 s66, 1600000
    s_cbranch_scc1 L_uc_spin
L_uc_go:

    s_waitcnt vmcnt(24)
    s_add_u32 m0, s52, 0
    s_add_u32 s58, s54, 0
    buffer_load_dwordx4 v20, s[20:23], s58 offen offset:0  lds
    s_sub_u32 s61, s56, 3
    s_max_u32 s60, s60, s61
    v_mov_b32 v14, s60
    ds_write_b32 v16, v14 offset:0

    s_waitcnt vmcnt(24)
    buffer_load_dwordx4 v21, s[20:23], s58 offen offset:1024  lds
    s_waitcnt vmcnt(24)
    buffer_load_dwordx4 v22, s[20:23], s58 offen offset:2048  lds
    s_waitcnt vmcnt(24)
    buffer_load_dwordx4 v23, s[20:23], s58 offen offset:3072  lds
    s_waitcnt vmcnt(24)
    s_add_u32 m0, s52, 4096
    s_add_u32 s58, s54, 65536
    buffer_load_dwordx4 v20, s[20:23], s58 offen offset:0  lds
    s_waitcnt vmcnt(24)
    buffer_load_dwordx4 v21, s[20:23], s58 offen offset:1024  lds
    s_waitcnt vmcnt(24)
    buffer_load_dwordx4 v22, s[20:23], s58 offen offset:2048  lds
    s_waitcnt vmcnt(24)
    buffer_load_dwordx4 v23, s[20:23], s58 offen offset:3072  lds
    s_waitcnt vmcnt(24)
    s_add_u32 m0, s52, 8192
    s_add_u32 s58, s54, 131072
    buffer_load_dwordx4 v20, s[20:23], s58 offen offset:0  lds
    s_waitcnt vmcnt(24)
    buffer_load_dwordx4 v21, s[20:23], s58 offen offset:1024  lds
    s_waitcnt vmcnt(24)
    buffer_load_dwordx4 v22, s[20:23], s58 offen offset:2048  lds
    s_waitcnt vmcnt(24)
    buffer_load_dwordx4 v23, s[20:23], s58 offen offset:3072  lds
    s_waitcnt vmcnt(24)
    s_add_u32 m0, s52, 12288
    s_add_u32 s58, s54, 196608
    buffer_load_dwordx4 v20, s[20:23], s58 offen offset:0  lds
    s_sub_u32 s61, s56, 2
    s_max_u32 s60, s60, s61
    v_mov_b32 v14, s60
    ds_write_b32 v16, v14 offset:0

    s_waitcnt vmcnt(24)
    buffer_load_dwordx4 v21, s[20:23], s58 offen offset:1024  lds
    s_waitcnt vmcnt(24)
    buffer_load_dwordx4 v22, s[20:23], s58 offen offset:2048  lds
    s_waitcnt vmcnt(24)
    buffer_load_dwordx4 v23, s[20:23], s58 offen offset:3072  lds
    s_waitcnt vmcnt(24)
    s_add_u32 m0, s52, 16384
    s_add_u32 s58, s54, 262144
    buffer_load_dwordx4 v20, s[20:23], s58 offen offset:0  lds
    s_waitcnt vmcnt(24)
    buffer_load_dwordx4 v21, s[20:23], s58 offen offset:1024  lds
    s_waitcnt vmcnt(24)
    buffer_load_dwordx4 v22, s[20:23], s58 offen offset:2048  lds
    s_waitcnt vmcnt(24)
    buffer_load_dwordx4 v23, s[20:23], s58 offen offset:3072  lds
    s_waitcnt vmcnt(24)
    s_add_u32 m0, s52, 20480
    s_add_u32 s58, s54, 327680
    buffer_load_dwordx4 v20, s[20:23], s58 offen offset:0  lds
    s_waitcnt vmcnt(24)
    buffer_load_dwordx4 v21, s[20:23], s58 offen offset:1024  lds
    s_waitcnt vmcnt(24)
    buffer_load_dwordx4 v22, s[20:23], s58 offen offset:2048  lds
    s_waitcnt vmcnt(24)
    buffer_load_dwordx4 v23, s[20:23], s58 offen offset:3072  lds
    s_waitcnt vmcnt(24)
    s_add_u32 m0, s52, 24576
    s_add_u32 s58, s54, 393216
    buffer_load_dwordx4 v20, s[20:23], s58 offen offset:0  lds
    s_sub_u32 s61, s56, 1
    s_max_u32 s60, s60, s61
    v_mov_b32 v14, s60
    ds_write_b32 v16, v14 offset:0

    s_waitcnt vmcnt(24)
    buffer_load_dwordx4 v21, s[20:23], s58 offen offset:1024  lds
    s_waitcnt vmcnt(24)
    buffer_load_dwordx4 v22, s[20:23], s58 offen offset:2048  lds
    s_waitcnt vmcnt(24)
    buffer_load_dwordx4 v23, s[20:23], s58 offen offset:3072  lds
    ds_read_b32 v17, v16 offset:1024
    s_waitcnt vmcnt(24)
    s_add_u32 m0, s52, 28672
    s_add_u32 s58, s54, 458752
    buffer_load_dwordx4 v20, s[20:23], s58 offen offset:0  lds
    s_waitcnt vmcnt(24)
    buffer_load_dwordx4 v21, s[20:23], s58 offen offset:1024  lds
    s_waitcnt vmcnt(24)
    buffer_load_dwordx4 v22, s[20:23], s58 offen offset:2048  lds
    s_waitcnt vmcnt(24)
    buffer_load_dwordx4 v23, s[20:23], s58 offen offset:3072  lds
    s_add_u32 s54, s54, 128
    s_and_b32 s54, s54, 2047
    s_add_u32 s52, s52, 32768
    s_cmp_ge_u32 s52, 102400
    s_cselect_b32 s52, 4096, s52

    s_add_u32 s56, s56, 1
    s_cmp_lt_u32 s56, 49
    s_cbranch_scc1 L_ld_loop

    s_sub_i32 s59, s56, 9
    s_waitcnt lgkmcnt(0)
    v_cmp_gt_i32 vcc, s59, v17
    s_mov_b32 s66, 0
    s_cbranch_vccz L_ud_go

    ds_read_b32 v17, v16 offset:1024
    s_waitcnt lgkmcnt(0)
    v_cmp_gt_i32 vcc, s59, v17
    s_nop 0
    s_cbranch_vccz L_ud_go

    s_waitcnt vmcnt(0)
    s_sub_u32 s61, s56, 1
    s_max_u32 s60, s60, s61
    v_mov_b32 v14, s60
    ds_write_b32 v16, v14 offset:0

L_ud_spin:
    ds_read_b32 v17, v16 offset:1024
    s_waitcnt lgkmcnt(0)
    v_cmp_gt_i32 vcc, s59, v17
    s_add_u32 s66, s66, 1
    s_cbranch_vccz L_ud_go
    s_sleep 1
    s_cmp_lt_u32 s66, 1600000
    s_cbranch_scc1 L_ud_spin
L_ud_go:

    s_waitcnt vmcnt(24)
    s_add_u32 m0, s53, 0
    s_add_u32 s58, s55, 0
    buffer_load_dwordx4 v24, s[24:27], s58 offen offset:0  lds
    s_waitcnt vmcnt(24)
    buffer_load_dwordx4 v25, s[24:27], s58 offen offset:1024  lds
    s_waitcnt vmcnt(24)
    buffer_load_dwordx4 v26, s[24:27], s58 offen offset:2048  lds
    s_waitcnt vmcnt(24)
    buffer_load_dwordx4 v27, s[24:27], s58 offen offset:3072  lds
    s_waitcnt vmcnt(24)
    s_add_u32 m0, s53, 4096
    s_add_u32 s58, s55, 2048
    buffer_load_dwordx4 v24, s[24:27], s58 offen offset:0  lds
    s_waitcnt vmcnt(24)
    buffer_load_dwordx4 v25, s[24:27], s58 offen offset:1024  lds
    s_waitcnt vmcnt(24)
    buffer_load_dwordx4 v26, s[24:27], s58 offen offset:2048  lds
    s_waitcnt vmcnt(24)
    buffer_load_dwordx4 v27, s[24:27], s58 offen offset:3072  lds
    ds_read_b32 v17, v16 offset:1024
    s_waitcnt vmcnt(24)
    s_add_u32 m0, s53, 8192
    s_add_u32 s58, s55, 4096
    buffer_load_dwordx4 v24, s[24:27], s58 offen offset:0  lds
    s_waitcnt vmcnt(24)
    buffer_load_dwordx4 v25, s[24:27], s58 offen offset:1024  lds
    s_waitcnt vmcnt(24)
    buffer_load_dwordx4 v26, s[24:27], s58 offen offset:2048  lds
    s_waitcnt vmcnt(24)
    buffer_load_dwordx4 v27, s[24:27], s58 offen offset:3072  lds
    s_add_u32 s55, s55, 196608
    s_cmp_ge_u32 s55, 6291456
    s_cselect_b32 s55, 0, s55
    s_add_u32 s53, s53, 12288
    s_cmp_ge_u32 s53, 163840
    s_cselect_b32 s53, 102400, s53

    s_add_u32 s56, s56, 1
    s_waitcnt vmcnt(44)
    s_sub_u32 s61, s56, 3
    s_max_u32 s60, s60, s61
    v_mov_b32 v14, s60
    ds_write_b32 v16, v14 offset:0

    s_waitcnt vmcnt(12)
    s_sub_u32 s61, s56, 2
    s_max_u32 s60, s60, s61
    v_mov_b32 v14, s60
    ds_write_b32 v16, v14 offset:0

    s_waitcnt vmcnt(0)
    s_mov_b32 s56, 1001

    s_sub_u32 s61, s56, 1
    s_max_u32 s60, s60, s61
    v_mov_b32 v14, s60
    ds_write_b32 v16, v14 offset:0

    s_setprio 0
    v_mov_b32 v16, 0
    s_branch L_hold
L_cons:
    s_lshr_b32 s50, s41, 1
    s_and_b32 s51, s41, 1
    v_lshlrev_b32 v12, 4, v0
    v_mov_b32 v16, 0
    v_mov_b32 v17, 0
    v_mov_b32 v18, 0
    v_mov_b32 v19, 0
    ds_write_b128 v12, v[16:19]
    v_mov_b32 v5, v1
    v_and_b32 v12, 15, v5
    s_lshl_b32 s52, s50, 7
    v_add_u32 v12, s52, v12
    v_lshlrev_b32 v12, 7, v12
    v_lshrrev_b32 v13, 4, v5
    v_bfe_u32 v14, v5, 1, 3
    v_xor_b32 v13, v13, v14
    v_lshlrev_b32 v13, 4, v13
    v_add_u32 v12, v12, v13
    v_add_u32 v0, 69632, v12
    v_lshrrev_b32 v12, 4, v5
    v_lshlrev_b32 v13, 10, v12
    v_bfe_u32 v14, v5, 2, 2
    v_lshlrev_b32 v15, 7, v14
    v_add_u32 v13, v13, v15
    v_and_b32 v14, 2, v14
    v_and_b32 v12, 1, v12
    v_or_b32 v12, v12, v14
    s_lshl_b32 s52, s51, 1
    v_xor_b32 v12, s52, v12
    v_lshlrev_b32 v12, 5, v12
    v_add_u32 v13, v13, v12
    v_and_b32 v12, 3, v5
    v_lshlrev_b32 v12, 3, v12
    v_add_u32 v13, v13, v12
    v_add_u32 v1, 102400, v13
    v_xor_b32 v5, 32, v1
    s_lshl_b32 s52, s41, 8
    s_mov_b32 m0, s52
    v_mov_b32 v4, 1
    s_mov_b32 s76, 1069066811
    s_mov_b32 s77, 1069066811
    s_mov_b32 s78, 897988541
    s_lshl_b32 s58, s51, 2
    s_mul_i32 s59, s41, 5120
    s_add_u32 s59, s59, 4096
    s_lshl_b32 s62, s44, 1
    s_add_u32 s62, s62, s51
    s_lshl_b32 s69, s45, 1
    s_add_u32 s69, s69, s50
    s_lshl_b32 s69, s69, 6
    s_add_u32 s69, s69, s62
    s_lshl_b32 s69, s69, 4
    s_add_u32 s69, s69, 11534336
    s_lshl_b32 s64, s45, 3
    s_lshl_b32 s61, s50, 2
    s_add_u32 s64, s64, s61
    s_add_u32 s64, s64, s46
    s_lshl_b32 s64, s64, 17
    s_lshl_b32 s61, s47, 13
    s_add_u32 s64, s64, s61
    s_lshl_b32 s61, s51, 12
    s_add_u32 s64, s64, s61
    s_add_u32 s65, s64, 262144
    s_mul_i32 s74, s51, 3072
    s_add_u32 s74, s74, 24576

    s_waitcnt lgkmcnt(0)
    s_mov_b32 s20, s4
    s_mov_b32 s21, s5
    s_mov_b32 s22, 0x400000
    s_mov_b32 s23, 0x20000
    s_cmp_eq_u32 s46, 0
    s_cselect_b32 s24, s6, s8
    s_cselect_b32 s25, s7, s9
    s_mov_b32 s26, 0x600000
    s_mov_b32 s27, 0x20000
    s_mov_b32 s28, s14
    s_mov_b32 s29, s15
    s_mov_b32 s30, 0x10000000
    s_mov_b32 s31, 0x20000

    v_mov_b32 v64, s78
    v_mov_b32 v65, s78
    v_mov_b32 v66, s78
    v_mov_b32 v67, s78
    v_mov_b32 v68, s78
    v_mov_b32 v69, s78
    v_mov_b32 v70, s78
    v_mov_b32 v71, s78
    v_mov_b32 v72, s78
    v_mov_b32 v73, s78
    v_mov_b32 v74, s78
    v_mov_b32 v75, s78
    v_mov_b32 v76, s78
    v_mov_b32 v77, s78
    v_mov_b32 v78, s78
    v_mov_b32 v79, s78
    v_mov_b32 v80, s78
    v_mov_b32 v81, s78
    v_mov_b32 v82, s78
    v_mov_b32 v83, s78
    v_mov_b32 v84, s78
    v_mov_b32 v85, s78
    v_mov_b32 v86, s78
    v_mov_b32 v87, s78
    v_mov_b32 v88, s78
    v_mov_b32 v89, s78
    v_mov_b32 v90, s78
    v_mov_b32 v91, s78
    v_mov_b32 v92, s78
    v_mov_b32 v93, s78
    v_mov_b32 v94, s78
    v_mov_b32 v95, s78
    v_mov_b32 v96, s78
    v_mov_b32 v97, s78
    v_mov_b32 v98, s78
    v_mov_b32 v99, s78
    v_mov_b32 v100, s78
    v_mov_b32 v101, s78
    v_mov_b32 v102, s78
    v_mov_b32 v103, s78
    v_mov_b32 v104, s78
    v_mov_b32 v105, s78
    v_mov_b32 v106, s78
    v_mov_b32 v107, s78
    v_mov_b32 v108, s78
    v_mov_b32 v109, s78
    v_mov_b32 v110, s78
    v_mov_b32 v111, s78
    v_mov_b32 v112, s78
    v_mov_b32 v113, s78
    v_mov_b32 v114, s78
    v_mov_b32 v115, s78
    v_mov_b32 v116, s78
    v_mov_b32 v117, s78
    v_mov_b32 v118, s78
    v_mov_b32 v119, s78
    v_mov_b32 v120, s78
    v_mov_b32 v121, s78
    v_mov_b32 v122, s78
    v_mov_b32 v123, s78
    v_mov_b32 v124, s78
    v_mov_b32 v125, s78
    v_mov_b32 v126, s78
    v_mov_b32 v127, s78
    v_mov_b32 v128, s78
    v_mov_b32 v129, s78
    v_mov_b32 v130, s78
    v_mov_b32 v131, s78
    v_mov_b32 v132, s78
    v_mov_b32 v133, s78
    v_mov_b32 v134, s78
    v_mov_b32 v135, s78
    v_mov_b32 v136, s78
    v_mov_b32 v137, s78
    v_mov_b32 v138, s78
    v_mov_b32 v139, s78
    v_mov_b32 v140, s78
    v_mov_b32 v141, s78
    v_mov_b32 v142, s78
    v_mov_b32 v143, s78
    v_mov_b32 v144, s78
    v_mov_b32 v145, s78
    v_mov_b32 v146, s78
    v_mov_b32 v147, s78
    v_mov_b32 v148, s78
    v_mov_b32 v149, s78
    v_mov_b32 v150, s78
    v_mov_b32 v151, s78
    v_mov_b32 v152, s78
    v_mov_b32 v153, s78
    v_mov_b32 v154, s78
    v_mov_b32 v155, s78
    v_mov_b32 v156, s78
    v_mov_b32 v157, s78
    v_mov_b32 v158, s78
    v_mov_b32 v159, s78
    s_waitcnt lgkmcnt(0)
    s_barrier

    v_mov_b32 v160, s78
    v_mov_b32 v161, s78
    v_mov_b32 v162, s78
    v_mov_b32 v163, s78
    v_mov_b32 v164, s78
    v_mov_b32 v165, s78
    v_mov_b32 v166, s78
    v_mov_b32 v167, s78
    v_mov_b32 v168, s78
    v_mov_b32 v169, s78
    v_mov_b32 v170, s78
    v_mov_b32 v171, s78
    v_mov_b32 v172, s78
    v_mov_b32 v173, s78
    v_mov_b32 v174, s78
    v_mov_b32 v175, s78
    v_mov_b32 v176, s78
    v_mov_b32 v177, s78
    v_mov_b32 v178, s78
    v_mov_b32 v179, s78
    v_mov_b32 v180, s78
    v_mov_b32 v181, s78
    v_mov_b32 v182, s78
    v_mov_b32 v183, s78
    v_mov_b32 v184, s78
    v_mov_b32 v185, s78
    v_mov_b32 v186, s78
    v_mov_b32 v187, s78
    v_mov_b32 v188, s78
    v_mov_b32 v189, s78
    v_mov_b32 v190, s78
    v_mov_b32 v191, s78
    v_mov_b32 v192, 0
    v_mov_b32 v193, 0
    v_mov_b32 v194, 0
    v_mov_b32 v195, 0
    v_mov_b32 v196, 0
    v_mov_b32 v197, 0
    v_mov_b32 v198, 0
    v_mov_b32 v199, 0
    v_mov_b32 v200, 0
    v_mov_b32 v201, 0
    v_mov_b32 v202, 0
    v_mov_b32 v203, 0
    v_mov_b32 v204, 0
    v_mov_b32 v205, 0
    v_mov_b32 v206, 0
    v_mov_b32 v207, 0
    v_mov_b32 v208, 0
    v_mov_b32 v209, 0
    v_mov_b32 v210, 0
    v_mov_b32 v211, 0
    v_mov_b32 v212, 0
    v_mov_b32 v213, 0
    v_mov_b32 v214, 0
    v_mov_b32 v215, 0
    v_mov_b32 v216, 0
    v_mov_b32 v217, 0
    v_mov_b32 v218, 0
    v_mov_b32 v219, 0
    v_mov_b32 v220, 0
    v_mov_b32 v221, 0
    v_mov_b32 v222, 0
    v_mov_b32 v223, 0
    v_mov_b32 v224, 0
    v_mov_b32 v225, 0
    v_mov_b32 v226, 0
    v_mov_b32 v227, 0
    v_mov_b32 v228, 0
    v_mov_b32 v229, 0
    v_mov_b32 v230, 0
    v_mov_b32 v231, 0
    v_mov_b32 v232, 0
    v_mov_b32 v233, 0
    v_mov_b32 v234, 0
    v_mov_b32 v235, 0
    v_mov_b32 v236, 0
    v_mov_b32 v237, 0
    v_mov_b32 v238, 0
    v_mov_b32 v239, 0
    v_mov_b32 v240, 0
    v_mov_b32 v241, 0
    v_mov_b32 v242, 0
    v_mov_b32 v243, 0
    v_mov_b32 v244, 0
    v_mov_b32 v245, 0
    v_mov_b32 v246, 0
    v_mov_b32 v247, 0
    v_mov_b32 v248, 0
    v_mov_b32 v249, 0
    v_mov_b32 v250, 0
    v_mov_b32 v251, 0
    v_mov_b32 v252, 0
    v_mov_b32 v253, 0
    v_mov_b32 v254, 0
    v_mov_b32 v255, 0
    s_mov_b32 s52, 2
    s_mov_b32 s53, 0
    s_mov_b32 s54, 0
    s_mov_b32 s55, 3
    s_mov_b32 s70, 4294918144
    s_mov_b32 s71, 12288
    s_mov_b32 s72, 4294901760
    s_mov_b32 s73, 32768

    s_mov_b32 s63, 0
L_c_spin0:
    ds_read_addtid_b32 v6 offset:0
    s_waitcnt lgkmcnt(0)
    v_cmp_gt_u32 vcc, s55, v6
    s_add_u32 s63, s63, 1
    s_cmp_ge_u32 s63, 1600000
    s_cbranch_scc1 L_c_spin0_out
    s_and_b32 s56, vcc_lo, 7
    s_cbranch_scc1 L_c_spin0
L_c_spin0_out:

    s_waitcnt vmcnt(0)
    ds_read_b128 v[8:11], v0 offset:0
    ds_read_b128 v[12:15], v0 offset:2048
    ds_read_b128 v[16:19], v0 offset:4096
    ds_read_b128 v[20:23], v0 offset:6144
    ds_read_b64_tr_b16 v[40:41], v1 offset:0
    ds_read_b64_tr_b16 v[42:43], v1 offset:512
    ds_read_b64_tr_b16 v[44:45], v5 offset:0
    ds_read_b64_tr_b16 v[46:47], v5 offset:512
    ds_read_b64_tr_b16 v[48:49], v1 offset:4096
    ds_read_b64_tr_b16 v[50:51], v1 offset:4608
    ds_read_b64_tr_b16 v[52:53], v5 offset:4096
    ds_read_b64_tr_b16 v[54:55], v5 offset:4608
    ds_read_b64_tr_b16 v[56:57], v1 offset:8192
    ds_read_b64_tr_b16 v[58:59], v1 offset:8704
    s_waitcnt lgkmcnt(0)
    s_branch L_c_loop
L_c_slow0:
    s_mov_b32 s63, 0
L_c_slow0_sp:
    ds_read_addtid_b32 v6 offset:0
    s_waitcnt lgkmcnt(0)
    v_cmp_gt_u32 vcc, s55, v6
    s_add_u32 s63, s63, 1
    s_cmp_ge_u32 s63, 1600000
    s_cbranch_scc1 L_c_slow0_sp_out
    s_and_b32 s56, vcc_lo, 7
    s_cbranch_scc1 L_c_slow0_sp
L_c_slow0_sp_out:

    s_branch L_c_slow0_ret
L_c_slow1:
    s_mov_b32 s63, 0
L_c_slow1_sp:
    ds_read_addtid_b32 v6 offset:0
    s_waitcnt lgkmcnt(0)
    v_cmp_gt_u32 vcc, s55, v6
    s_add_u32 s63, s63, 1
    s_cmp_ge_u32 s63, 1600000
    s_cbranch_scc1 L_c_slow1_sp_out
    s_and_b32 s56, vcc_lo, 7
    s_cbranch_scc1 L_c_slow1_sp
L_c_slow1_sp_out:

    s_branch L_c_slow1_ret
L_c_slowt0:
    s_mov_b32 s63, 0
L_c_slowt0_sp:
    ds_read_addtid_b32 v6 offset:0
    s_waitcnt lgkmcnt(0)
    v_cmp_gt_u32 vcc, s55, v6
    s_add_u32 s63, s63, 1
    s_cmp_ge_u32 s63, 1600000
    s_cbranch_scc1 L_c_slowt0_sp_out
    s_and_b32 s56, vcc_lo, 7
    s_cbranch_scc1 L_c_slowt0_sp
L_c_slowt0_sp_out:

    s_branch L_c_slowt0_ret
L_c_slowt1:
    s_mov_b32 s63, 0
L_c_slowt1_sp:
    ds_read_addtid_b32 v6 offset:0
    s_waitcnt lgkmcnt(0)
    v_cmp_gt_u32 vcc, s55, v6
    s_add_u32 s63, s63, 1
    s_cmp_ge_u32 s63, 1600000
    s_cbranch_scc1 L_c_slowt1_sp_out
    s_and_b32 s56, vcc_lo, 7
    s_cbranch_scc1 L_c_slowt1_sp
L_c_slowt1_sp_out:

    s_branch L_c_slowt1_ret
L_c_slowt2:
    s_mov_b32 s63, 0
L_c_slowt2_sp:
    ds_read_addtid_b32 v6 offset:0
    s_waitcnt lgkmcnt(0)
    v_cmp_gt_u32 vcc, s55, v6
    s_add_u32 s63, s63, 1
    s_cmp_ge_u32 s63, 1600000
    s_cbranch_scc1 L_c_slowt2_sp_out
    s_and_b32 s56, vcc_lo, 7
    s_cbranch_scc1 L_c_slowt2_sp
L_c_slowt2_sp_out:

    s_branch L_c_slowt2_ret
    .p2align 6
L_c_loop:
    s_waitcnt lgkmcnt(8)
    v_mfma_f32_16x16x32_bf16 v[64:67], v[40:43], v[8:11], v[64:67]
    ds_read_b64_tr_b16 v[60:61], v5 offset:8192
    v_mfma_f32_16x16x32_bf16 v[68:71], v[40:43], v[12:15], v[68:71]
    ds_read_b64_tr_b16 v[62:63], v5 offset:8704
    v_mfma_f32_16x16x32_bf16 v[72:75], v[40:43], v[16:19], v[72:75]
    ds_write_addtid_b32 v4 offset:1024
    v_mfma_f32_16x16x32_bf16 v[76:79], v[40:43], v[20:23], v[76:79]
    s_add_u32 s53, s53, 1
    s_cmp_eq_u32 s53, 5
    s_waitcnt lgkmcnt(9)
    v_mfma_f32_16x16x32_bf16 v[108:111], v[44:47], v[20:23], v[108:111]
    ds_read_addtid_b32 v6 offset:0
    s_cselect_b32 s53, 0, s53
    v_mfma_f32_16x16x32_bf16 v[104:107], v[44:47], v[16:19], v[104:107]
    ds_read_b128 v[24:27], v0 offset:8192
    s_cselect_b32 s57, s70, s71
    v_mfma_f32_16x16x32_bf16 v[100:103], v[44:47], v[12:15], v[100:103]
    v_add_u32 v1, s57, v1
    v_mfma_f32_16x16x32_bf16 v[96:99], v[44:47], v[8:11], v[96:99]
    ds_read_b128 v[28:31], v0 offset:10240
    s_waitcnt lgkmcnt(10)
    v_mfma_f32_16x16x32_bf16 v[128:131], v[8:11], v[48:51], v[128:131]
    v_add_u32 v5, s57, v5
    v_mfma_f32_16x16x32_bf16 v[132:135], v[12:15], v[48:51], v[132:135]
    ds_read_b128 v[32:35], v0 offset:12288
    v_mfma_f32_16x16x32_bf16 v[136:139], v[16:19], v[48:51], v[136:139]
    v_add_u32 v4, 1, v4
    v_mfma_f32_16x16x32_bf16 v[140:143], v[20:23], v[48:51], v[140:143]
    ds_read_b128 v[36:39], v0 offset:14336
    s_waitcnt lgkmcnt(10)
    v_mfma_f32_16x16x32_bf16 v[172:175], v[20:23], v[52:55], v[172:175]
    v_mfma_f32_16x16x32_bf16 v[168:171], v[16:19], v[52:55], v[168:171]
    s_add_u32 s55, s55, 1
    v_mfma_f32_16x16x32_bf16 v[164:167], v[12:15], v[52:55], v[164:167]
    v_xor_b32 v0, 64, v0
    v_mfma_f32_16x16x32_bf16 v[160:163], v[8:11], v[52:55], v[160:163]
    s_waitcnt lgkmcnt(8)
    v_mfma_f32_16x16x32_bf16 v[192:195], v[8:11], v[56:59], v[192:195]
    v_mfma_f32_16x16x32_bf16 v[196:199], v[12:15], v[56:59], v[196:199]
    v_mfma_f32_16x16x32_bf16 v[200:203], v[16:19], v[56:59], v[200:203]
    v_mfma_f32_16x16x32_bf16 v[204:207], v[20:23], v[56:59], v[204:207]
    s_waitcnt lgkmcnt(4)
    v_mfma_f32_16x16x32_bf16 v[236:239], v[20:23], v[60:63], v[236:239]
    v_cmp_gt_u32 vcc, s55, v6
    v_mfma_f32_16x16x32_bf16 v[232:235], v[16:19], v[60:63], v[232:235]
    v_mfma_f32_16x16x32_bf16 v[228:231], v[12:15], v[60:63], v[228:231]
    s_and_b32 s56, vcc_lo, 7
    v_mfma_f32_16x16x32_bf16 v[224:227], v[8:11], v[60:63], v[224:227]
    s_cbranch_scc1 L_c_slow0
L_c_slow0_ret:
    s_waitcnt lgkmcnt(0)
    v_mfma_f32_16x16x32_bf16 v[80:83], v[40:43], v[24:27], v[80:83]
    ds_read_b128 v[8:11], v0 offset:0
    v_mfma_f32_16x16x32_bf16 v[84:87], v[40:43], v[28:31], v[84:87]
    ds_read_b128 v[12:15], v0 offset:2048
    v_mfma_f32_16x16x32_bf16 v[88:91], v[40:43], v[32:35], v[88:91]
    ds_read_b128 v[16:19], v0 offset:4096
    v_mfma_f32_16x16x32_bf16 v[92:95], v[40:43], v[36:39], v[92:95]
    v_mfma_f32_16x16x32_bf16 v[124:127], v[44:47], v[36:39], v[124:127]
    ds_read_b64_tr_b16 v[40:41], v1 offset:0
    v_mfma_f32_16x16x32_bf16 v[120:123], v[44:47], v[32:35], v[120:123]
    ds_read_b64_tr_b16 v[42:43], v1 offset:512
    v_mfma_f32_16x16x32_bf16 v[116:119], v[44:47], v[28:31], v[116:119]
    ds_read_b128 v[20:23], v0 offset:6144
    v_mfma_f32_16x16x32_bf16 v[112:115], v[44:47], v[24:27], v[112:115]
    v_mfma_f32_16x16x32_bf16 v[144:147], v[24:27], v[48:51], v[144:147]
    ds_read_b64_tr_b16 v[44:45], v5 offset:0
    v_mfma_f32_16x16x32_bf16 v[148:151], v[28:31], v[48:51], v[148:151]
    ds_read_b64_tr_b16 v[46:47], v5 offset:512
    v_mfma_f32_16x16x32_bf16 v[152:155], v[32:35], v[48:51], v[152:155]
    v_mfma_f32_16x16x32_bf16 v[156:159], v[36:39], v[48:51], v[156:159]
    v_mfma_f32_16x16x32_bf16 v[188:191], v[36:39], v[52:55], v[188:191]
    ds_read_b64_tr_b16 v[48:49], v1 offset:4096
    v_mfma_f32_16x16x32_bf16 v[184:187], v[32:35], v[52:55], v[184:187]
    ds_read_b64_tr_b16 v[50:51], v1 offset:4608
    v_mfma_f32_16x16x32_bf16 v[180:183], v[28:31], v[52:55], v[180:183]
    v_mfma_f32_16x16x32_bf16 v[176:179], v[24:27], v[52:55], v[176:179]
    v_mfma_f32_16x16x32_bf16 v[208:211], v[24:27], v[56:59], v[208:211]
    ds_read_b64_tr_b16 v[52:53], v5 offset:4096
    v_mfma_f32_16x16x32_bf16 v[212:215], v[28:31], v[56:59], v[212:215]
    ds_read_b64_tr_b16 v[54:55], v5 offset:4608
    v_mfma_f32_16x16x32_bf16 v[216:219], v[32:35], v[56:59], v[216:219]
    v_mfma_f32_16x16x32_bf16 v[220:223], v[36:39], v[56:59], v[220:223]
    v_mfma_f32_16x16x32_bf16 v[252:255], v[36:39], v[60:63], v[252:255]
    ds_read_b64_tr_b16 v[56:57], v1 offset:8192
    v_mfma_f32_16x16x32_bf16 v[248:251], v[32:35], v[60:63], v[248:251]
    ds_read_b64_tr_b16 v[58:59], v1 offset:8704
    v_mfma_f32_16x16x32_bf16 v[244:247], v[28:31], v[60:63], v[244:247]
    v_mfma_f32_16x16x32_bf16 v[240:243], v[24:27], v[60:63], v[240:243]
    s_waitcnt lgkmcnt(8)
    v_mfma_f32_16x16x32_bf16 v[64:67], v[40:43], v[8:11], v[64:67]
    ds_read_b64_tr_b16 v[60:61], v5 offset:8192
    v_mfma_f32_16x16x32_bf16 v[68:71], v[40:43], v[12:15], v[68:71]
    ds_read_b64_tr_b16 v[62:63], v5 offset:8704
    v_mfma_f32_16x16x32_bf16 v[72:75], v[40:43], v[16:19], v[72:75]
    ds_write_addtid_b32 v4 offset:1024
    v_mfma_f32_16x16x32_bf16 v[76:79], v[40:43], v[20:23], v[76:79]
    s_add_u32 s53, s53, 1
    s_cmp_eq_u32 s53, 5
    s_waitcnt lgkmcnt(9)
    v_mfma_f32_16x16x32_bf16 v[108:111], v[44:47], v[20:23], v[108:111]
    ds_read_addtid_b32 v6 offset:0
    s_cselect_b32 s53, 0, s53
    v_mfma_f32_16x16x32_bf16 v[104:107], v[44:47], v[16:19], v[104:107]
    ds_read_b128 v[24:27], v0 offset:8192
    s_cselect_b32 s57, s70, s71
    v_mfma_f32_16x16x32_bf16 v[100:103], v[44:47], v[12:15], v[100:103]
    v_add_u32 v1, s57, v1
    v_mfma_f32_16x16x32_bf16 v[96:99], v[44:47], v[8:11], v[96:99]
    ds_read_b128 v[28:31], v0 offset:10240
    s_waitcnt lgkmcnt(10)
    v_mfma_f32_16x16x32_bf16 v[128:131], v[8:11], v[48:51], v[128:131]
    v_add_u32 v5, s57, v5
    v_mfma_f32_16x16x32_bf16 v[132:135], v[12:15], v[48:51], v[132:135]
    ds_read_b128 v[32:35], v0 offset:12288
    v_mfma_f32_16x16x32_bf16 v[136:139], v[16:19], v[48:51], v[136:139]
    v_add_u32 v4, 1, v4
    v_mfma_f32_16x16x32_bf16 v[140:143], v[20:23], v[48:51], v[140:143]
    ds_read_b128 v[36:39], v0 offset:14336
    s_waitcnt lgkmcnt(10)
    v_mfma_f32_16x16x32_bf16 v[172:175], v[20:23], v[52:55], v[172:175]
    ds_write_addtid_b32 v4 offset:1024
    v_mfma_f32_16x16x32_bf16 v[168:171], v[16:19], v[52:55], v[168:171]
    s_add_u32 s55, s55, 2
    v_mfma_f32_16x16x32_bf16 v[164:167], v[12:15], v[52:55], v[164:167]
    s_add_u32 s52, s52, 1
    s_cmp_eq_u32 s52, 3
    v_mfma_f32_16x16x32_bf16 v[160:163], v[8:11], v[52:55], v[160:163]
    s_cselect_b32 s52, 0, s52
    s_cselect_b32 s57, s72, s73
    s_waitcnt lgkmcnt(9)
    v_mfma_f32_16x16x32_bf16 v[192:195], v[8:11], v[56:59], v[192:195]
    v_xor_b32 v0, 64, v0
    v_mfma_f32_16x16x32_bf16 v[196:199], v[12:15], v[56:59], v[196:199]
    v_add_u32 v0, s57, v0
    v_mfma_f32_16x16x32_bf16 v[200:203], v[16:19], v[56:59], v[200:203]
    v_add_u32 v4, 1, v4
    v_mfma_f32_16x16x32_bf16 v[204:207], v[20:23], v[56:59], v[204:207]
    s_waitcnt lgkmcnt(5)
    v_mfma_f32_16x16x32_bf16 v[236:239], v[20:23], v[60:63], v[236:239]
    v_cmp_gt_u32 vcc, s55, v6
    v_mfma_f32_16x16x32_bf16 v[232:235], v[16:19], v[60:63], v[232:235]
    v_mfma_f32_16x16x32_bf16 v[228:231], v[12:15], v[60:63], v[228:231]
    s_and_b32 s56, vcc_lo, 7
    v_mfma_f32_16x16x32_bf16 v[224:227], v[8:11], v[60:63], v[224:227]
    s_cbranch_scc1 L_c_slow1
L_c_slow1_ret:
    s_waitcnt lgkmcnt(1)
    v_mfma_f32_16x16x32_bf16 v[80:83], v[40:43], v[24:27], v[80:83]
    ds_read_b128 v[8:11], v0 offset:0
    v_mfma_f32_16x16x32_bf16 v[84:87], v[40:43], v[28:31], v[84:87]
    ds_read_b128 v[12:15], v0 offset:2048
    v_mfma_f32_16x16x32_bf16 v[88:91], v[40:43], v[32:35], v[88:91]
    ds_read_b128 v[16:19], v0 offset:4096
    v_mfma_f32_16x16x32_bf16 v[92:95], v[40:43], v[36:39], v[92:95]
    v_mfma_f32_16x16x32_bf16 v[124:127], v[44:47], v[36:39], v[124:127]
    ds_read_b64_tr_b16 v[40:41], v1 offset:0
    v_mfma_f32_16x16x32_bf16 v[120:123], v[44:47], v[32:35], v[120:123]
    ds_read_b64_tr_b16 v[42:43], v1 offset:512
    v_mfma_f32_16x16x32_bf16 v[116:119], v[44:47], v[28:31], v[116:119]
    ds_read_b128 v[20:23], v0 offset:6144
    v_mfma_f32_16x16x32_bf16 v[112:115], v[44:47], v[24:27], v[112:115]
    v_mfma_f32_16x16x32_bf16 v[144:147], v[24:27], v[48:51], v[144:147]
    ds_read_b64_tr_b16 v[44:45], v5 offset:0
    v_mfma_f32_16x16x32_bf16 v[148:151], v[28:31], v[48:51], v[148:151]
    ds_read_b64_tr_b16 v[46:47], v5 offset:512
    v_mfma_f32_16x16x32_bf16 v[152:155], v[32:35], v[48:51], v[152:155]
    v_mfma_f32_16x16x32_bf16 v[156:159], v[36:39], v[48:51], v[156:159]
    v_mfma_f32_16x16x32_bf16 v[188:191], v[36:39], v[52:55], v[188:191]
    ds_read_b64_tr_b16 v[48:49], v1 offset:4096
    v_mfma_f32_16x16x32_bf16 v[184:187], v[32:35], v[52:55], v[184:187]
    ds_read_b64_tr_b16 v[50:51], v1 offset:4608
    v_mfma_f32_16x16x32_bf16 v[180:183], v[28:31], v[52:55], v[180:183]
    v_mfma_f32_16x16x32_bf16 v[176:179], v[24:27], v[52:55], v[176:179]
    v_mfma_f32_16x16x32_bf16 v[208:211], v[24:27], v[56:59], v[208:211]
    ds_read_b64_tr_b16 v[52:53], v5 offset:4096
    v_mfma_f32_16x16x32_bf16 v[212:215], v[28:31], v[56:59], v[212:215]
    ds_read_b64_tr_b16 v[54:55], v5 offset:4608
    v_mfma_f32_16x16x32_bf16 v[216:219], v[32:35], v[56:59], v[216:219]
    v_mfma_f32_16x16x32_bf16 v[220:223], v[36:39], v[56:59], v[220:223]
    s_add_u32 s54, s54, 1
    v_mfma_f32_16x16x32_bf16 v[252:255], v[36:39], v[60:63], v[252:255]
    ds_read_b64_tr_b16 v[56:57], v1 offset:8192
    v_mfma_f32_16x16x32_bf16 v[248:251], v[32:35], v[60:63], v[248:251]
    ds_read_b64_tr_b16 v[58:59], v1 offset:8704
    v_mfma_f32_16x16x32_bf16 v[244:247], v[28:31], v[60:63], v[244:247]
    s_cmp_lt_u32 s54, 14
    v_mfma_f32_16x16x32_bf16 v[240:243], v[24:27], v[60:63], v[240:243]
    s_cbranch_scc1 L_c_loop
    s_waitcnt lgkmcnt(4)
    v_mfma_f32_16x16x32_bf16 v[128:131], v[8:11], v[48:51], v[128:131]
    ds_read_b64_tr_b16 v[60:61], v5 offset:8192
    v_mfma_f32_16x16x32_bf16 v[132:135], v[12:15], v[48:51], v[132:135]
    ds_read_b64_tr_b16 v[62:63], v5 offset:8704
    v_mfma_f32_16x16x32_bf16 v[136:139], v[16:19], v[48:51], v[136:139]
    ds_read_addtid_b32 v6 offset:0
    v_mfma_f32_16x16x32_bf16 v[140:143], v[20:23], v[48:51], v[140:143]
    ds_read_b128 v[24:27], v0 offset:8192
    s_waitcnt lgkmcnt(6)
    v_mfma_f32_16x16x32_bf16 v[172:175], v[20:23], v[52:55], v[172:175]
    ds_read_b128 v[28:31], v0 offset:10240
    v_mfma_f32_16x16x32_bf16 v[168:171], v[16:19], v[52:55], v[168:171]
    ds_read_b128 v[32:35], v0 offset:12288
    v_mfma_f32_16x16x32_bf16 v[164:167], v[12:15], v[52:55], v[164:167]
    ds_read_b128 v[36:39], v0 offset:14336
    v_mfma_f32_16x16x32_bf16 v[160:163], v[8:11], v[52:55], v[160:163]
    s_add_u32 s55, s55, 1
    s_waitcnt lgkmcnt(7)
    v_mfma_f32_16x16x32_bf16 v[192:195], v[8:11], v[56:59], v[192:195]
    v_xor_b32 v40, 64, v0
    v_mfma_f32_16x16x32_bf16 v[196:199], v[12:15], v[56:59], v[196:199]
    v_subrev_u32 v41, 36864, v1
    v_mfma_f32_16x16x32_bf16 v[200:203], v[16:19], v[56:59], v[200:203]
    v_subrev_u32 v42, 36864, v5
    v_mfma_f32_16x16x32_bf16 v[204:207], v[20:23], v[56:59], v[204:207]
    s_waitcnt lgkmcnt(4)
    v_mfma_f32_16x16x32_bf16 v[236:239], v[20:23], v[60:63], v[236:239]
    v_cmp_gt_u32 vcc, s55, v6
    v_mfma_f32_16x16x32_bf16 v[232:235], v[16:19], v[60:63], v[232:235]
    v_mfma_f32_16x16x32_bf16 v[228:231], v[12:15], v[60:63], v[228:231]
    s_and_b32 s56, vcc_lo, 7
    v_mfma_f32_16x16x32_bf16 v[224:227], v[8:11], v[60:63], v[224:227]
    s_cbranch_scc1 L_c_slowt0
L_c_slowt0_ret:
    s_waitcnt lgkmcnt(0)
    v_mfma_f32_16x16x32_bf16 v[144:147], v[24:27], v[48:51], v[144:147]
    ds_read_b128 v[8:11], v40 offset:0
    v_mfma_f32_16x16x32_bf16 v[148:151], v[28:31], v[48:51], v[148:151]
    ds_read_b128 v[12:15], v40 offset:2048
    v_mfma_f32_16x16x32_bf16 v[152:155], v[32:35], v[48:51], v[152:155]
    ds_read_b128 v[16:19], v40 offset:4096
    v_mfma_f32_16x16x32_bf16 v[156:159], v[36:39], v[48:51], v[156:159]
    v_mfma_f32_16x16x32_bf16 v[188:191], v[36:39], v[52:55], v[188:191]
    ds_read_b64_tr_b16 v[48:49], v1 offset:16384
    v_mfma_f32_16x16x32_bf16 v[184:187], v[32:35], v[52:55], v[184:187]
    ds_read_b64_tr_b16 v[50:51], v1 offset:16896
    v_mfma_f32_16x16x32_bf16 v[180:183], v[28:31], v[52:55], v[180:183]
    ds_read_b128 v[20:23], v40 offset:6144
    v_mfma_f32_16x16x32_bf16 v[176:179], v[24:27], v[52:55], v[176:179]
    v_mfma_f32_16x16x32_bf16 v[208:211], v[24:27], v[56:59], v[208:211]
    ds_read_b64_tr_b16 v[52:53], v5 offset:16384
    v_mfma_f32_16x16x32_bf16 v[212:215], v[28:31], v[56:59], v[212:215]
    ds_read_b64_tr_b16 v[54:55], v5 offset:16896
    v_mfma_f32_16x16x32_bf16 v[216:219], v[32:35], v[56:59], v[216:219]
    v_mfma_f32_16x16x32_bf16 v[220:223], v[36:39], v[56:59], v[220:223]
    v_mfma_f32_16x16x32_bf16 v[252:255], v[36:39], v[60:63], v[252:255]
    ds_read_b64_tr_b16 v[56:57], v1 offset:20480
    v_mfma_f32_16x16x32_bf16 v[248:251], v[32:35], v[60:63], v[248:251]
    ds_read_b64_tr_b16 v[58:59], v1 offset:20992
    v_mfma_f32_16x16x32_bf16 v[244:247], v[28:31], v[60:63], v[244:247]
    v_mfma_f32_16x16x32_bf16 v[240:243], v[24:27], v[60:63], v[240:243]
    s_waitcnt lgkmcnt(4)
    v_mfma_f32_16x16x32_bf16 v[128:131], v[8:11], v[48:51], v[128:131]
    ds_read_b64_tr_b16 v[60:61], v5 offset:20480
    v_mfma_f32_16x16x32_bf16 v[132:135], v[12:15], v[48:51], v[132:135]
    ds_read_b64_tr_b16 v[62:63], v5 offset:20992
    v_mfma_f32_16x16x32_bf16 v[136:139], v[16:19], v[48:51], v[136:139]
    ds_read_addtid_b32 v6 offset:0
    v_mfma_f32_16x16x32_bf16 v[140:143], v[20:23], v[48:51], v[140:143]
    ds_read_b128 v[24:27], v40 offset:8192
    s_waitcnt lgkmcnt(6)
    v_mfma_f32_16x16x32_bf16 v[172:175], v[20:23], v[52:55], v[172:175]
    ds_read_b128 v[28:31], v40 offset:10240
    v_mfma_f32_16x16x32_bf16 v[168:171], v[16:19], v[52:55], v[168:171]
    ds_read_b128 v[32:35], v40 offset:12288
    v_mfma_f32_16x16x32_bf16 v[164:167], v[12:15], v[52:55], v[164:167]
    ds_read_b128 v[36:39], v40 offset:14336
    v_mfma_f32_16x16x32_bf16 v[160:163], v[8:11], v[52:55], v[160:163]
    s_add_u32 s55, s55, 2
    s_waitcnt lgkmcnt(7)
    v_mfma_f32_16x16x32_bf16 v[192:195], v[8:11], v[56:59], v[192:195]
    v_mfma_f32_16x16x32_bf16 v[196:199], v[12:15], v[56:59], v[196:199]
    v_mfma_f32_16x16x32_bf16 v[200:203], v[16:19], v[56:59], v[200:203]
    v_mfma_f32_16x16x32_bf16 v[204:207], v[20:23], v[56:59], v[204:207]
    s_waitcnt lgkmcnt(4)
    v_mfma_f32_16x16x32_bf16 v[236:239], v[20:23], v[60:63], v[236:239]
    v_cmp_gt_u32 vcc, s55, v6
    v_mfma_f32_16x16x32_bf16 v[232:235], v[16:19], v[60:63], v[232:235]
    v_mfma_f32_16x16x32_bf16 v[228:231], v[12:15], v[60:63], v[228:231]
    s_and_b32 s56, vcc_lo, 7
    v_mfma_f32_16x16x32_bf16 v[224:227], v[8:11], v[60:63], v[224:227]
    s_cbranch_scc1 L_c_slowt1
L_c_slowt1_ret:
    s_waitcnt lgkmcnt(0)
    v_mfma_f32_16x16x32_bf16 v[144:147], v[24:27], v[48:51], v[144:147]
    ds_read_b128 v[8:11], v0 offset:32768
    v_mfma_f32_16x16x32_bf16 v[148:151], v[28:31], v[48:51], v[148:151]
    ds_read_b128 v[12:15], v0 offset:34816
    v_mfma_f32_16x16x32_bf16 v[152:155], v[32:35], v[48:51], v[152:155]
    ds_read_b128 v[16:19], v0 offset:36864
    v_mfma_f32_16x16x32_bf16 v[156:159], v[36:39], v[48:51], v[156:159]
    v_mfma_f32_16x16x32_bf16 v[188:191], v[36:39], v[52:55], v[188:191]
    ds_read_b64_tr_b16 v[48:49], v41 offset:4096
    v_mfma_f32_16x16x32_bf16 v[184:187], v[32:35], v[52:55], v[184:187]
    ds_read_b64_tr_b16 v[50:51], v41 offset:4608
    v_mfma_f32_16x16x32_bf16 v[180:183], v[28:31], v[52:55], v[180:183]
    ds_read_b128 v[20:23], v0 offset:38912
    v_mfma_f32_16x16x32_bf16 v[176:179], v[24:27], v[52:55], v[176:179]
    v_mfma_f32_16x16x32_bf16 v[208:211], v[24:27], v[56:59], v[208:211]
    ds_read_b64_tr_b16 v[52:53], v42 offset:4096
    v_mfma_f32_16x16x32_bf16 v[212:215], v[28:31], v[56:59], v[212:215]
    ds_read_b64_tr_b16 v[54:55], v42 offset:4608
    v_mfma_f32_16x16x32_bf16 v[216:219], v[32:35], v[56:59], v[216:219]
    v_mfma_f32_16x16x32_bf16 v[220:223], v[36:39], v[56:59], v[220:223]
    v_mfma_f32_16x16x32_bf16 v[252:255], v[36:39], v[60:63], v[252:255]
    ds_read_b64_tr_b16 v[56:57], v41 offset:8192
    v_mfma_f32_16x16x32_bf16 v[248:251], v[32:35], v[60:63], v[248:251]
    ds_read_b64_tr_b16 v[58:59], v41 offset:8704
    v_mfma_f32_16x16x32_bf16 v[244:247], v[28:31], v[60:63], v[244:247]
    v_mfma_f32_16x16x32_bf16 v[240:243], v[24:27], v[60:63], v[240:243]
    s_waitcnt lgkmcnt(4)
    v_mfma_f32_16x16x32_bf16 v[128:131], v[8:11], v[48:51], v[128:131]
    ds_read_b64_tr_b16 v[60:61], v42 offset:8192
    v_mfma_f32_16x16x32_bf16 v[132:135], v[12:15], v[48:51], v[132:135]
    ds_read_b64_tr_b16 v[62:63], v42 offset:8704
    v_mfma_f32_16x16x32_bf16 v[136:139], v[16:19], v[48:51], v[136:139]
    ds_read_addtid_b32 v6 offset:0
    v_mfma_f32_16x16x32_bf16 v[140:143], v[20:23], v[48:51], v[140:143]
    ds_read_b128 v[24:27], v0 offset:40960
    s_waitcnt lgkmcnt(6)
    v_mfma_f32_16x16x32_bf16 v[172:175], v[20:23], v[52:55], v[172:175]
    ds_read_b128 v[28:31], v0 offset:43008
    v_mfma_f32_16x16x32_bf16 v[168:171], v[16:19], v[52:55], v[168:171]
    ds_read_b128 v[32:35], v0 offset:45056
    v_mfma_f32_16x16x32_bf16 v[164:167], v[12:15], v[52:55], v[164:167]
    ds_read_b128 v[36:39], v0 offset:47104
    v_mfma_f32_16x16x32_bf16 v[160:163], v[8:11], v[52:55], v[160:163]
    s_add_u32 s55, s55, 1
    s_waitcnt lgkmcnt(7)
    v_mfma_f32_16x16x32_bf16 v[192:195], v[8:11], v[56:59], v[192:195]
    v_mfma_f32_16x16x32_bf16 v[196:199], v[12:15], v[56:59], v[196:199]
    v_mfma_f32_16x16x32_bf16 v[200:203], v[16:19], v[56:59], v[200:203]
    v_mfma_f32_16x16x32_bf16 v[204:207], v[20:23], v[56:59], v[204:207]
    s_waitcnt lgkmcnt(4)
    v_mfma_f32_16x16x32_bf16 v[236:239], v[20:23], v[60:63], v[236:239]
    v_cmp_gt_u32 vcc, s55, v6
    v_mfma_f32_16x16x32_bf16 v[232:235], v[16:19], v[60:63], v[232:235]
    v_mfma_f32_16x16x32_bf16 v[228:231], v[12:15], v[60:63], v[228:231]
    s_and_b32 s56, vcc_lo, 7
    v_mfma_f32_16x16x32_bf16 v[224:227], v[8:11], v[60:63], v[224:227]
    s_cbranch_scc1 L_c_slowt2
L_c_slowt2_ret:
    s_waitcnt lgkmcnt(0)
    v_mfma_f32_16x16x32_bf16 v[144:147], v[24:27], v[48:51], v[144:147]
    ds_read_b128 v[8:11], v40 offset:32768
    v_mfma_f32_16x16x32_bf16 v[148:151], v[28:31], v[48:51], v[148:151]
    ds_read_b128 v[12:15], v40 offset:34816
    v_mfma_f32_16x16x32_bf16 v[152:155], v[32:35], v[48:51], v[152:155]
    ds_read_b128 v[16:19], v40 offset:36864
    v_mfma_f32_16x16x32_bf16 v[156:159], v[36:39], v[48:51], v[156:159]
    v_mfma_f32_16x16x32_bf16 v[188:191], v[36:39], v[52:55], v[188:191]
    ds_read_b64_tr_b16 v[48:49], v41 offset:16384
    v_mfma_f32_16x16x32_bf16 v[184:187], v[32:35], v[52:55], v[184:187]
    ds_read_b64_tr_b16 v[50:51], v41 offset:16896
    v_mfma_f32_16x16x32_bf16 v[180:183], v[28:31], v[52:55], v[180:183]
    ds_read_b128 v[20:23], v40 offset:38912
    v_mfma_f32_16x16x32_bf16 v[176:179], v[24:27], v[52:55], v[176:179]
    v_mfma_f32_16x16x32_bf16 v[208:211], v[24:27], v[56:59], v[208:211]
    ds_read_b64_tr_b16 v[52:53], v42 offset:16384
    v_mfma_f32_16x16x32_bf16 v[212:215], v[28:31], v[56:59], v[212:215]
    ds_read_b64_tr_b16 v[54:55], v42 offset:16896
    v_mfma_f32_16x16x32_bf16 v[216:219], v[32:35], v[56:59], v[216:219]
    v_mfma_f32_16x16x32_bf16 v[220:223], v[36:39], v[56:59], v[220:223]
    v_mfma_f32_16x16x32_bf16 v[252:255], v[36:39], v[60:63], v[252:255]
    ds_read_b64_tr_b16 v[56:57], v41 offset:20480
    v_mfma_f32_16x16x32_bf16 v[248:251], v[32:35], v[60:63], v[248:251]
    ds_read_b64_tr_b16 v[58:59], v41 offset:20992
    v_mfma_f32_16x16x32_bf16 v[244:247], v[28:31], v[60:63], v[244:247]
    v_mfma_f32_16x16x32_bf16 v[240:243], v[24:27], v[60:63], v[240:243]
    s_waitcnt lgkmcnt(4)
    v_mfma_f32_16x16x32_bf16 v[128:131], v[8:11], v[48:51], v[128:131]
    ds_read_b64_tr_b16 v[60:61], v42 offset:20480
    v_mfma_f32_16x16x32_bf16 v[132:135], v[12:15], v[48:51], v[132:135]
    ds_read_b64_tr_b16 v[62:63], v42 offset:20992
    v_mfma_f32_16x16x32_bf16 v[136:139], v[16:19], v[48:51], v[136:139]
    v_mfma_f32_16x16x32_bf16 v[140:143], v[20:23], v[48:51], v[140:143]
    ds_read_b128 v[24:27], v40 offset:40960
    s_waitcnt lgkmcnt(5)
    v_mfma_f32_16x16x32_bf16 v[172:175], v[20:23], v[52:55], v[172:175]
    ds_read_b128 v[28:31], v40 offset:43008
    v_mfma_f32_16x16x32_bf16 v[168:171], v[16:19], v[52:55], v[168:171]
    ds_read_b128 v[32:35], v40 offset:45056
    v_mfma_f32_16x16x32_bf16 v[164:167], v[12:15], v[52:55], v[164:167]
    ds_read_b128 v[36:39], v40 offset:47104
    v_mfma_f32_16x16x32_bf16 v[160:163], v[8:11], v[52:55], v[160:163]
    s_waitcnt lgkmcnt(6)
    v_mfma_f32_16x16x32_bf16 v[192:195], v[8:11], v[56:59], v[192:195]
    v_mfma_f32_16x16x32_bf16 v[196:199], v[12:15], v[56:59], v[196:199]
    v_mfma_f32_16x16x32_bf16 v[200:203], v[16:19], v[56:59], v[200:203]
    v_mfma_f32_16x16x32_bf16 v[204:207], v[20:23], v[56:59], v[204:207]
    v_mov_b32 v4, 46
    s_waitcnt lgkmcnt(4)
    v_mfma_f32_16x16x32_bf16 v[236:239], v[20:23], v[60:63], v[236:239]
    v_mfma_f32_16x16x32_bf16 v[232:235], v[16:19], v[60:63], v[232:235]
    ds_write_addtid_b32 v4 offset:1024
    v_mfma_f32_16x16x32_bf16 v[228:231], v[12:15], v[60:63], v[228:231]
    v_mfma_f32_16x16x32_bf16 v[224:227], v[8:11], v[60:63], v[224:227]
    s_waitcnt lgkmcnt(1)
    v_mfma_f32_16x16x32_bf16 v[144:147], v[24:27], v[48:51], v[144:147]
    v_mfma_f32_16x16x32_bf16 v[148:151], v[28:31], v[48:51], v[148:151]
    v_mfma_f32_16x16x32_bf16 v[152:155], v[32:35], v[48:51], v[152:155]
    v_mfma_f32_16x16x32_bf16 v[156:159], v[36:39], v[48:51], v[156:159]
    v_mfma_f32_16x16x32_bf16 v[188:191], v[36:39], v[52:55], v[188:191]
    v_mfma_f32_16x16x32_bf16 v[184:187], v[32:35], v[52:55], v[184:187]
    v_mfma_f32_16x16x32_bf16 v[180:183], v[28:31], v[52:55], v[180:183]
    v_mfma_f32_16x16x32_bf16 v[176:179], v[24:27], v[52:55], v[176:179]
    v_mfma_f32_16x16x32_bf16 v[208:211], v[24:27], v[56:59], v[208:211]
    v_mfma_f32_16x16x32_bf16 v[212:215], v[28:31], v[56:59], v[212:215]
    v_mfma_f32_16x16x32_bf16 v[216:219], v[32:35], v[56:59], v[216:219]
    v_mfma_f32_16x16x32_bf16 v[220:223], v[36:39], v[56:59], v[220:223]
    v_mfma_f32_16x16x32_bf16 v[252:255], v[36:39], v[60:63], v[252:255]
    v_mfma_f32_16x16x32_bf16 v[248:251], v[32:35], v[60:63], v[248:251]
    v_mfma_f32_16x16x32_bf16 v[244:247], v[28:31], v[60:63], v[244:247]
    v_mfma_f32_16x16x32_bf16 v[240:243], v[24:27], v[60:63], v[240:243]
    s_waitcnt lgkmcnt(0)
    v_mov_b32 v56, v0
    v_mov_b32 v57, v40
    v_mov_b32 v58, v1
    v_mov_b32 v59, v5
    v_mov_b32 v60, v41
    v_mov_b32 v61, v42
    v_mbcnt_lo_u32_b32 v1, -1, 0
    v_mbcnt_hi_u32_b32 v1, -1, v1
    v_lshlrev_b32 v2, 4, v1
    v_mov_b32 v54, 3049366176

    v_mov_b32 v32, 0x3f803f80
    v_mov_b32 v33, 0x3f803f80
    v_mov_b32 v34, 0x3f803f80
    v_mov_b32 v35, 0x3f803f80
    v_pk_fma_f32 v[36:37], v[128:129], s[76:77], v[54:55] op_sel_hi:[1,1,0]
    v_pk_fma_f32 v[38:39], v[130:131], s[76:77], v[54:55] op_sel_hi:[1,1,0]
    v_pk_fma_f32 v[40:41], v[132:133], s[76:77], v[54:55] op_sel_hi:[1,1,0]
    v_pk_fma_f32 v[42:43], v[134:135], s[76:77], v[54:55] op_sel_hi:[1,1,0]
    v_exp_f32 v36, v36 clamp
    v_max_f32 v128, s78, v128
    v_exp_f32 v37, v37 clamp
    v_max_f32 v129, s78, v129
    v_exp_f32 v38, v38 clamp
    v_max_f32 v130, s78, v130
    v_exp_f32 v39, v39 clamp
    v_max_f32 v131, s78, v131
    v_exp_f32 v40, v40 clamp
    v_max_f32 v132, s78, v132
    v_exp_f32 v41, v41 clamp
    v_max_f32 v133, s78, v133
    v_exp_f32 v42, v42 clamp
    v_max_f32 v134, s78, v134
    v_exp_f32 v43, v43 clamp
    v_max_f32 v135, s78, v135
    v_cvt_pk_bf16_f32 v192, v192, v193
    v_cvt_pk_bf16_f32 v193, v194, v195
    v_cvt_pk_bf16_f32 v194, v196, v197
    v_cvt_pk_bf16_f32 v195, v198, v199
    v_cvt_pk_bf16_f32 v224, v224, v225
    v_cvt_pk_bf16_f32 v225, v226, v227
    v_cvt_pk_bf16_f32 v226, v228, v229
    v_cvt_pk_bf16_f32 v227, v230, v231
    v_pk_add_f32 v[128:129], v[128:129], v[36:37]
    v_pk_add_f32 v[130:131], v[130:131], v[38:39]
    v_pk_add_f32 v[132:133], v[132:133], v[40:41]
    v_pk_add_f32 v[134:135], v[134:135], v[42:43]
    v_cvt_pk_bf16_f32 v128, v128, v129
    v_cvt_pk_bf16_f32 v129, v130, v131
    v_cvt_pk_bf16_f32 v130, v132, v133
    v_cvt_pk_bf16_f32 v131, v134, v135
    v_pk_fma_f32 v[44:45], v[160:161], s[76:77], v[54:55] op_sel_hi:[1,1,0]
    v_pk_fma_f32 v[46:47], v[162:163], s[76:77], v[54:55] op_sel_hi:[1,1,0]
    v_pk_fma_f32 v[48:49], v[164:165], s[76:77], v[54:55] op_sel_hi:[1,1,0]
    v_mfma_f32_16x16x32_bf16 v[8:11], v[128:131], v[192:195], 0
    v_pk_fma_f32 v[50:51], v[166:167], s[76:77], v[54:55] op_sel_hi:[1,1,0]
    v_exp_f32 v44, v44 clamp
    v_max_f32 v160, s78, v160
    v_exp_f32 v45, v45 clamp
    v_mfma_f32_16x16x32_bf16 v[12:15], v[128:131], v[224:227], 0
    v_max_f32 v161, s78, v161
    v_exp_f32 v46, v46 clamp
    v_max_f32 v162, s78, v162
    v_exp_f32 v47, v47 clamp
    v_mfma_f32_16x16x32_bf16 v[24:27], v[128:131], v[32:35], 0
    v_max_f32 v163, s78, v163
    v_exp_f32 v48, v48 clamp
    v_max_f32 v164, s78, v164
    v_exp_f32 v49, v49 clamp
    v_max_f32 v165, s78, v165
    v_exp_f32 v50, v50 clamp
    v_max_f32 v166, s78, v166
    v_exp_f32 v51, v51 clamp
    v_max_f32 v167, s78, v167
    v_pk_add_f32 v[160:161], v[160:161], v[44:45]
    v_pk_add_f32 v[162:163], v[162:163], v[46:47]
    v_pk_add_f32 v[164:165], v[164:165], v[48:49]
    v_pk_add_f32 v[166:167], v[166:167], v[50:51]
    v_cvt_pk_bf16_f32 v160, v160, v161
    v_cvt_pk_bf16_f32 v161, v162, v163
    v_cvt_pk_bf16_f32 v162, v164, v165
    v_cvt_pk_bf16_f32 v163, v166, v167
    v_pk_fma_f32 v[36:37], v[136:137], s[76:77], v[54:55] op_sel_hi:[1,1,0]
    v_pk_fma_f32 v[38:39], v[138:139], s[76:77], v[54:55] op_sel_hi:[1,1,0]
    v_pk_fma_f32 v[40:41], v[140:141], s[76:77], v[54:55] op_sel_hi:[1,1,0]
    v_mfma_f32_16x16x32_bf16 v[16:19], v[160:163], v[192:195], 0
    v_pk_fma_f32 v[42:43], v[142:143], s[76:77], v[54:55] op_sel_hi:[1,1,0]
    v_exp_f32 v36, v36 clamp
    v_max_f32 v136, s78, v136
    v_exp_f32 v37, v37 clamp
    v_mfma_f32_16x16x32_bf16 v[20:23], v[160:163], v[224:227], 0
    v_max_f32 v137, s78, v137
    v_exp_f32 v38, v38 clamp
    v_max_f32 v138, s78, v138
    v_exp_f32 v39, v39 clamp
    v_mfma_f32_16x16x32_bf16 v[28:31], v[160:163], v[32:35], 0
    v_max_f32 v139, s78, v139
    v_exp_f32 v40, v40 clamp
    v_max_f32 v140, s78, v140
    v_exp_f32 v41, v41 clamp
    v_max_f32 v141, s78, v141
    v_exp_f32 v42, v42 clamp
    v_max_f32 v142, s78, v142
    v_exp_f32 v43, v43 clamp
    v_max_f32 v143, s78, v143
    v_cvt_pk_bf16_f32 v200, v200, v201
    v_cvt_pk_bf16_f32 v201, v202, v203
    v_cvt_pk_bf16_f32 v202, v204, v205
    v_cvt_pk_bf16_f32 v203, v206, v207
    v_cvt_pk_bf16_f32 v232, v232, v233
    v_cvt_pk_bf16_f32 v233, v234, v235
    v_cvt_pk_bf16_f32 v234, v236, v237
    v_cvt_pk_bf16_f32 v235, v238, v239
    v_pk_add_f32 v[136:137], v[136:137], v[36:37]
    v_pk_add_f32 v[138:139], v[138:139], v[38:39]
    v_pk_add_f32 v[140:141], v[140:141], v[40:41]
    v_pk_add_f32 v[142:143], v[142:143], v[42:43]
    v_cvt_pk_bf16_f32 v136, v136, v137
    v_cvt_pk_bf16_f32 v137, v138, v139
    v_cvt_pk_bf16_f32 v138, v140, v141
    v_cvt_pk_bf16_f32 v139, v142, v143
    v_pk_fma_f32 v[44:45], v[168:169], s[76:77], v[54:55] op_sel_hi:[1,1,0]
    v_pk_fma_f32 v[46:47], v[170:171], s[76:77], v[54:55] op_sel_hi:[1,1,0]
    v_pk_fma_f32 v[48:49], v[172:173], s[76:77], v[54:55] op_sel_hi:[1,1,0]
    v_mfma_f32_16x16x32_bf16 v[8:11], v[136:139], v[200:203], v[8:11]
    v_pk_fma_f32 v[50:51], v[174:175], s[76:77], v[54:55] op_sel_hi:[1,1,0]
    v_exp_f32 v44, v44 clamp
    v_max_f32 v168, s78, v168
    v_exp_f32 v45, v45 clamp
    v_mfma_f32_16x16x32_bf16 v[12:15], v[136:139], v[232:235], v[12:15]
    v_max_f32 v169, s78, v169
    v_exp_f32 v46, v46 clamp
    v_max_f32 v170, s78, v170
    v_exp_f32 v47, v47 clamp
    v_mfma_f32_16x16x32_bf16 v[24:27], v[136:139], v[32:35], v[24:27]
    v_max_f32 v171, s78, v171
    v_exp_f32 v48, v48 clamp
    v_max_f32 v172, s78, v172
    v_exp_f32 v49, v49 clamp
    v_max_f32 v173, s78, v173
    v_exp_f32 v50, v50 clamp
    v_max_f32 v174, s78, v174
    v_exp_f32 v51, v51 clamp
    v_max_f32 v175, s78, v175
    v_pk_add_f32 v[168:169], v[168:169], v[44:45]
    v_pk_add_f32 v[170:171], v[170:171], v[46:47]
    v_pk_add_f32 v[172:173], v[172:173], v[48:49]
    v_pk_add_f32 v[174:175], v[174:175], v[50:51]
    v_cvt_pk_bf16_f32 v168, v168, v169
    v_cvt_pk_bf16_f32 v169, v170, v171
    v_cvt_pk_bf16_f32 v170, v172, v173
    v_cvt_pk_bf16_f32 v171, v174, v175
    v_pk_fma_f32 v[36:37], v[144:145], s[76:77], v[54:55] op_sel_hi:[1,1,0]
    v_pk_fma_f32 v[38:39], v[146:147], s[76:77], v[54:55] op_sel_hi:[1,1,0]
    v_pk_fma_f32 v[40:41], v[148:149], s[76:77], v[54:55] op_sel_hi:[1,1,0]
    v_mfma_f32_16x16x32_bf16 v[16:19], v[168:171], v[200:203], v[16:19]
    v_pk_fma_f32 v[42:43], v[150:151], s[76:77], v[54:55] op_sel_hi:[1,1,0]
    v_exp_f32 v36, v36 clamp
    v_max_f32 v144, s78, v144
    v_exp_f32 v37, v37 clamp
    v_mfma_f32_16x16x32_bf16 v[20:23], v[168:171], v[232:235], v[20:23]
    v_max_f32 v145, s78, v145
    v_exp_f32 v38, v38 clamp
    v_max_f32 v146, s78, v146
    v_exp_f32 v39, v39 clamp
    v_mfma_f32_16x16x32_bf16 v[28:31], v[168:171], v[32:35], v[28:31]
    v_max_f32 v147, s78, v147
    v_exp_f32 v40, v40 clamp
    v_max_f32 v148, s78, v148
    v_exp_f32 v41, v41 clamp
    v_max_f32 v149, s78, v149
    v_exp_f32 v42, v42 clamp
    v_max_f32 v150, s78, v150
    v_exp_f32 v43, v43 clamp
    v_max_f32 v151, s78, v151
    v_cvt_pk_bf16_f32 v208, v208, v209
    v_cvt_pk_bf16_f32 v209, v210, v211
    v_cvt_pk_bf16_f32 v210, v212, v213
    v_cvt_pk_bf16_f32 v211, v214, v215
    v_cvt_pk_bf16_f32 v240, v240, v241
    v_cvt_pk_bf16_f32 v241, v242, v243
    v_cvt_pk_bf16_f32 v242, v244, v245
    v_cvt_pk_bf16_f32 v243, v246, v247
    v_pk_add_f32 v[144:145], v[144:145], v[36:37]
    v_pk_add_f32 v[146:147], v[146:147], v[38:39]
    v_pk_add_f32 v[148:149], v[148:149], v[40:41]
    v_pk_add_f32 v[150:151], v[150:151], v[42:43]
    v_cvt_pk_bf16_f32 v144, v144, v145
    v_cvt_pk_bf16_f32 v145, v146, v147
    v_cvt_pk_bf16_f32 v146, v148, v149
    v_cvt_pk_bf16_f32 v147, v150, v151
    v_pk_fma_f32 v[44:45], v[176:177], s[76:77], v[54:55] op_sel_hi:[1,1,0]
    v_pk_fma_f32 v[46:47], v[178:179], s[76:77], v[54:55] op_sel_hi:[1,1,0]
    v_pk_fma_f32 v[48:49], v[180:181], s[76:77], v[54:55] op_sel_hi:[1,1,0]
    v_mfma_f32_16x16x32_bf16 v[8:11], v[144:147], v[208:211], v[8:11]
    v_pk_fma_f32 v[50:51], v[182:183], s[76:77], v[54:55] op_sel_hi:[1,1,0]
    v_exp_f32 v44, v44 clamp
    v_max_f32 v176, s78, v176
    v_exp_f32 v45, v45 clamp
    v_mfma_f32_16x16x32_bf16 v[12:15], v[144:147], v[240:243], v[12:15]
    v_max_f32 v177, s78, v177
    v_exp_f32 v46, v46 clamp
    v_max_f32 v178, s78, v178
    v_exp_f32 v47, v47 clamp
    v_mfma_f32_16x16x32_bf16 v[24:27], v[144:147], v[32:35], v[24:27]
    v_max_f32 v179, s78, v179
    v_exp_f32 v48, v48 clamp
    v_max_f32 v180, s78, v180
    v_exp_f32 v49, v49 clamp
    v_max_f32 v181, s78, v181
    v_exp_f32 v50, v50 clamp
    v_max_f32 v182, s78, v182
    v_exp_f32 v51, v51 clamp
    v_max_f32 v183, s78, v183
    v_pk_add_f32 v[176:177], v[176:177], v[44:45]
    v_pk_add_f32 v[178:179], v[178:179], v[46:47]
    v_pk_add_f32 v[180:181], v[180:181], v[48:49]
    v_pk_add_f32 v[182:183], v[182:183], v[50:51]
    v_cvt_pk_bf16_f32 v176, v176, v177
    v_cvt_pk_bf16_f32 v177, v178, v179
    v_cvt_pk_bf16_f32 v178, v180, v181
    v_cvt_pk_bf16_f32 v179, v182, v183
    v_pk_fma_f32 v[36:37], v[152:153], s[76:77], v[54:55] op_sel_hi:[1,1,0]
    v_pk_fma_f32 v[38:39], v[154:155], s[76:77], v[54:55] op_sel_hi:[1,1,0]
    v_pk_fma_f32 v[40:41], v[156:157], s[76:77], v[54:55] op_sel_hi:[1,1,0]
    v_mfma_f32_16x16x32_bf16 v[16:19], v[176:179], v[208:211], v[16:19]
    v_pk_fma_f32 v[42:43], v[158:159], s[76:77], v[54:55] op_sel_hi:[1,1,0]
    v_exp_f32 v36, v36 clamp
    v_max_f32 v152, s78, v152
    v_exp_f32 v37, v37 clamp
    v_mfma_f32_16x16x32_bf16 v[20:23], v[176:179], v[240:243], v[20:23]
    v_max_f32 v153, s78, v153
    v_exp_f32 v38, v38 clamp
    v_max_f32 v154, s78, v154
    v_exp_f32 v39, v39 clamp
    v_mfma_f32_16x16x32_bf16 v[28:31], v[176:179], v[32:35], v[28:31]
    v_max_f32 v155, s78, v155
    v_exp_f32 v40, v40 clamp
    v_max_f32 v156, s78, v156
    v_exp_f32 v41, v41 clamp
    v_max_f32 v157, s78, v157
    v_exp_f32 v42, v42 clamp
    v_max_f32 v158, s78, v158
    v_exp_f32 v43, v43 clamp
    v_max_f32 v159, s78, v159
    v_cvt_pk_bf16_f32 v216, v216, v217
    v_cvt_pk_bf16_f32 v217, v218, v219
    v_cvt_pk_bf16_f32 v218, v220, v221
    v_cvt_pk_bf16_f32 v219, v222, v223
    v_cvt_pk_bf16_f32 v248, v248, v249
    v_cvt_pk_bf16_f32 v249, v250, v251
    v_cvt_pk_bf16_f32 v250, v252, v253
    v_cvt_pk_bf16_f32 v251, v254, v255
    v_pk_add_f32 v[152:153], v[152:153], v[36:37]
    v_pk_add_f32 v[154:155], v[154:155], v[38:39]
    v_pk_add_f32 v[156:157], v[156:157], v[40:41]
    v_pk_add_f32 v[158:159], v[158:159], v[42:43]
    v_cvt_pk_bf16_f32 v152, v152, v153
    v_cvt_pk_bf16_f32 v153, v154, v155
    v_cvt_pk_bf16_f32 v154, v156, v157
    v_cvt_pk_bf16_f32 v155, v158, v159
    v_and_b32 v6, 3, v1
    v_lshlrev_b32 v6, 8, v6
    ds_read_b32 v52, v6 offset:1024

    v_pk_fma_f32 v[44:45], v[184:185], s[76:77], v[54:55] op_sel_hi:[1,1,0]
    v_pk_fma_f32 v[46:47], v[186:187], s[76:77], v[54:55] op_sel_hi:[1,1,0]
    v_pk_fma_f32 v[48:49], v[188:189], s[76:77], v[54:55] op_sel_hi:[1,1,0]
    v_mfma_f32_16x16x32_bf16 v[8:11], v[152:155], v[216:219], v[8:11]
    v_pk_fma_f32 v[50:51], v[190:191], s[76:77], v[54:55] op_sel_hi:[1,1,0]
    v_exp_f32 v44, v44 clamp
    v_max_f32 v184, s78, v184
    v_exp_f32 v45, v45 clamp
    v_mfma_f32_16x16x32_bf16 v[12:15], v[152:155], v[248:251], v[12:15]
    v_max_f32 v185, s78, v185
    v_exp_f32 v46, v46 clamp
    v_max_f32 v186, s78, v186
    v_exp_f32 v47, v47 clamp
    v_mfma_f32_16x16x32_bf16 v[24:27], v[152:155], v[32:35], v[24:27]
    v_max_f32 v187, s78, v187
    v_exp_f32 v48, v48 clamp
    v_max_f32 v188, s78, v188
    v_exp_f32 v49, v49 clamp
    v_max_f32 v189, s78, v189
    v_exp_f32 v50, v50 clamp
    v_max_f32 v190, s78, v190
    v_exp_f32 v51, v51 clamp
    v_max_f32 v191, s78, v191
    v_pk_add_f32 v[184:185], v[184:185], v[44:45]
    v_pk_add_f32 v[186:187], v[186:187], v[46:47]
    v_pk_add_f32 v[188:189], v[188:189], v[48:49]
    v_pk_add_f32 v[190:191], v[190:191], v[50:51]
    v_cvt_pk_bf16_f32 v184, v184, v185
    v_cvt_pk_bf16_f32 v185, v186, v187
    v_cvt_pk_bf16_f32 v186, v188, v189
    v_cvt_pk_bf16_f32 v187, v190, v191
    v_add_u32 v3, s59, v2
    v_and_b32 v55, 1, v1

    v_mfma_f32_16x16x32_bf16 v[16:19], v[184:187], v[216:219], v[16:19]
    v_cmp_eq_u32 s[90:91], 1, v55
    v_mfma_f32_16x16x32_bf16 v[20:23], v[184:187], v[248:251], v[20:23]
    v_and_b32 v55, 2, v1
    v_mfma_f32_16x16x32_bf16 v[28:31], v[184:187], v[32:35], v[28:31]
    v_cmp_eq_u32 s[92:93], 2, v55
    v_lshlrev_b32 v5, 2, v1
    v_add_u32 v5, s59, v5
    v_mov_b32 v53, 1
    s_mov_b32 s63, 0
L_e_b0:
    s_waitcnt lgkmcnt(0)
    v_cmp_gt_u32 vcc, 42, v52
    s_add_u32 s63, s63, 1
    s_cbranch_vccz L_e_b0ok
    s_cmp_ge_u32 s63, 1600000
    s_cbranch_scc1 L_e_b0ok
    ds_read_b32 v52, v6 offset:1024
    s_branch L_e_b0
L_e_b0ok:

    ds_write_b128 v3, v[8:11] offset:0
    ds_write_b128 v3, v[12:15] offset:1024
    v_cndmask_b32 v24, v24, v25, s[90:91]
    v_cndmask_b32 v26, v26, v27, s[90:91]
    v_cndmask_b32 v24, v24, v26, s[92:93]
    ds_write_b32 v5, v24 offset:4096
    ds_write_b128 v3, v[16:19] offset:2048
    ds_write_b128 v3, v[20:23] offset:3072
    v_cndmask_b32 v28, v28, v29, s[90:91]
    v_cndmask_b32 v30, v30, v31, s[90:91]
    v_cndmask_b32 v28, v28, v30, s[92:93]
    ds_write_b32 v5, v28 offset:4352
    ds_write_addtid_b32 v53 offset:3072
    s_waitcnt lgkmcnt(3)
    ds_read_b64_tr_b16 v[160:161], v58 offset:0
    ds_read_b64_tr_b16 v[162:163], v58 offset:512
    ds_read_b64_tr_b16 v[164:165], v59 offset:0
    ds_read_b64_tr_b16 v[166:167], v59 offset:512
    ds_read_b128 v[128:131], v56 offset:0
    ds_read_b128 v[132:135], v56 offset:2048
    ds_read_b128 v[136:139], v56 offset:4096
    ds_read_b128 v[140:143], v56 offset:6144
    ds_read_b128 v[144:147], v56 offset:8192
    ds_read_b128 v[148:151], v56 offset:10240
    ds_read_b128 v[152:155], v56 offset:12288
    ds_read_b128 v[156:159], v56 offset:14336
    v_mov_b32 v53, 48
    v_mov_b32 v40, 3049366176
    s_waitcnt lgkmcnt(4)
    v_mfma_f32_16x16x32_bf16 v[64:67], v[160:163], v[128:131], v[64:67]
    ds_read_b64_tr_b16 v[200:201], v58 offset:12288
    v_mfma_f32_16x16x32_bf16 v[96:99], v[164:167], v[128:131], v[96:99]
    ds_read_b64_tr_b16 v[202:203], v58 offset:12800
    v_mfma_f32_16x16x32_bf16 v[68:71], v[160:163], v[132:135], v[68:71]
    ds_read_b64_tr_b16 v[204:205], v59 offset:12288
    v_mfma_f32_16x16x32_bf16 v[100:103], v[164:167], v[132:135], v[100:103]
    ds_read_b64_tr_b16 v[206:207], v59 offset:12800
    v_mfma_f32_16x16x32_bf16 v[72:75], v[160:163], v[136:139], v[72:75]
    ds_read_b128 v[168:171], v57 offset:0
    v_mfma_f32_16x16x32_bf16 v[104:107], v[164:167], v[136:139], v[104:107]
    ds_read_b128 v[172:175], v57 offset:2048
    v_mfma_f32_16x16x32_bf16 v[76:79], v[160:163], v[140:143], v[76:79]
    ds_read_b128 v[176:179], v57 offset:4096
    v_mfma_f32_16x16x32_bf16 v[108:111], v[164:167], v[140:143], v[108:111]
    ds_read_b128 v[180:183], v57 offset:6144
    s_waitcnt lgkmcnt(8)
    v_mfma_f32_16x16x32_bf16 v[80:83], v[160:163], v[144:147], v[80:83]
    ds_read_b128 v[184:187], v57 offset:8192
    v_mfma_f32_16x16x32_bf16 v[112:115], v[164:167], v[144:147], v[112:115]
    ds_read_b128 v[188:191], v57 offset:10240
    v_mfma_f32_16x16x32_bf16 v[84:87], v[160:163], v[148:151], v[84:87]
    ds_read_b128 v[192:195], v57 offset:12288
    v_mfma_f32_16x16x32_bf16 v[116:119], v[164:167], v[148:151], v[116:119]
    ds_read_b128 v[196:199], v57 offset:14336
    v_mfma_f32_16x16x32_bf16 v[88:91], v[160:163], v[152:155], v[88:91]
    ds_read_b64_tr_b16 v[240:241], v60 offset:0
    v_mfma_f32_16x16x32_bf16 v[120:123], v[164:167], v[152:155], v[120:123]
    ds_read_b64_tr_b16 v[242:243], v60 offset:512
    v_mfma_f32_16x16x32_bf16 v[92:95], v[160:163], v[156:159], v[92:95]
    ds_read_b64_tr_b16 v[244:245], v61 offset:0
    v_mfma_f32_16x16x32_bf16 v[124:127], v[164:167], v[156:159], v[124:127]
    s_waitcnt lgkmcnt(7)
    v_mfma_f32_16x16x32_bf16 v[64:67], v[200:203], v[168:171], v[64:67]
    ds_read_b64_tr_b16 v[246:247], v61 offset:512
    v_mfma_f32_16x16x32_bf16 v[96:99], v[204:207], v[168:171], v[96:99]
    ds_read_b128 v[208:211], v56 offset:32768
    v_mfma_f32_16x16x32_bf16 v[68:71], v[200:203], v[172:175], v[68:71]
    ds_read_b128 v[212:215], v56 offset:34816
    v_mfma_f32_16x16x32_bf16 v[100:103], v[204:207], v[172:175], v[100:103]
    ds_read_b128 v[216:219], v56 offset:36864
    v_mfma_f32_16x16x32_bf16 v[72:75], v[200:203], v[176:179], v[72:75]
    ds_read_b128 v[220:223], v56 offset:38912
    v_mfma_f32_16x16x32_bf16 v[104:107], v[204:207], v[176:179], v[104:107]
    ds_read_b128 v[224:227], v56 offset:40960
    v_mfma_f32_16x16x32_bf16 v[76:79], v[200:203], v[180:183], v[76:79]
    ds_read_b128 v[228:231], v56 offset:43008
    v_mfma_f32_16x16x32_bf16 v[108:111], v[204:207], v[180:183], v[108:111]
    ds_read_b128 v[232:235], v56 offset:45056
    s_waitcnt lgkmcnt(11)
    v_mfma_f32_16x16x32_bf16 v[80:83], v[200:203], v[184:187], v[80:83]
    ds_read_b128 v[236:239], v56 offset:47104
    v_mfma_f32_16x16x32_bf16 v[112:115], v[204:207], v[184:187], v[112:115]
    ds_read_b64_tr_b16 v[160:161], v60 offset:12288
    v_mfma_f32_16x16x32_bf16 v[84:87], v[200:203], v[188:191], v[84:87]
    ds_read_b64_tr_b16 v[162:163], v60 offset:12800
    v_mfma_f32_16x16x32_bf16 v[116:119], v[204:207], v[188:191], v[116:119]
    ds_read_b64_tr_b16 v[164:165], v61 offset:12288
    v_mfma_f32_16x16x32_bf16 v[88:91], v[200:203], v[192:195], v[88:91]
    v_mfma_f32_16x16x32_bf16 v[120:123], v[204:207], v[192:195], v[120:123]
    v_mfma_f32_16x16x32_bf16 v[92:95], v[200:203], v[196:199], v[92:95]
    v_mfma_f32_16x16x32_bf16 v[124:127], v[204:207], v[196:199], v[124:127]
    s_waitcnt lgkmcnt(7)
    v_mfma_f32_16x16x32_bf16 v[64:67], v[240:243], v[208:211], v[64:67]
    ds_read_b64_tr_b16 v[166:167], v61 offset:12800
    v_mfma_f32_16x16x32_bf16 v[96:99], v[244:247], v[208:211], v[96:99]
    ds_read_b128 v[128:131], v57 offset:32768
    v_mfma_f32_16x16x32_bf16 v[68:71], v[240:243], v[212:215], v[68:71]
    ds_read_b128 v[132:135], v57 offset:34816
    v_mfma_f32_16x16x32_bf16 v[100:103], v[244:247], v[212:215], v[100:103]
    ds_read_b128 v[136:139], v57 offset:36864
    v_mfma_f32_16x16x32_bf16 v[72:75], v[240:243], v[216:219], v[72:75]
    ds_read_b128 v[140:143], v57 offset:38912
    v_mfma_f32_16x16x32_bf16 v[104:107], v[244:247], v[216:219], v[104:107]
    ds_read_b128 v[144:147], v57 offset:40960
    v_mfma_f32_16x16x32_bf16 v[76:79], v[240:243], v[220:223], v[76:79]
    ds_read_b128 v[148:151], v57 offset:43008
    v_mfma_f32_16x16x32_bf16 v[108:111], v[244:247], v[220:223], v[108:111]
    ds_read_b128 v[152:155], v57 offset:45056
    s_waitcnt lgkmcnt(11)
    v_mfma_f32_16x16x32_bf16 v[80:83], v[240:243], v[224:227], v[80:83]
    ds_read_b128 v[156:159], v57 offset:47104
    ds_write_addtid_b32 v53 offset:1024
    v_mfma_f32_16x16x32_bf16 v[112:115], v[244:247], v[224:227], v[112:115]
    v_mfma_f32_16x16x32_bf16 v[84:87], v[240:243], v[228:231], v[84:87]
    v_mfma_f32_16x16x32_bf16 v[116:119], v[244:247], v[228:231], v[116:119]
    v_mfma_f32_16x16x32_bf16 v[88:91], v[240:243], v[232:235], v[88:91]
    v_mfma_f32_16x16x32_bf16 v[120:123], v[244:247], v[232:235], v[120:123]
    v_mfma_f32_16x16x32_bf16 v[92:95], v[240:243], v[236:239], v[92:95]
    v_mfma_f32_16x16x32_bf16 v[124:127], v[244:247], v[236:239], v[124:127]
    s_waitcnt lgkmcnt(5)
    v_mfma_f32_16x16x32_bf16 v[64:67], v[160:163], v[128:131], v[64:67]
    v_mfma_f32_16x16x32_bf16 v[96:99], v[164:167], v[128:131], v[96:99]
    v_mfma_f32_16x16x32_bf16 v[68:71], v[160:163], v[132:135], v[68:71]
    v_mfma_f32_16x16x32_bf16 v[100:103], v[164:167], v[132:135], v[100:103]
    v_mfma_f32_16x16x32_bf16 v[72:75], v[160:163], v[136:139], v[72:75]
    v_mfma_f32_16x16x32_bf16 v[104:107], v[164:167], v[136:139], v[104:107]
    v_mfma_f32_16x16x32_bf16 v[76:79], v[160:163], v[140:143], v[76:79]
    v_mfma_f32_16x16x32_bf16 v[108:111], v[164:167], v[140:143], v[108:111]
    s_waitcnt lgkmcnt(1)
    v_mfma_f32_16x16x32_bf16 v[80:83], v[160:163], v[144:147], v[80:83]
    v_mfma_f32_16x16x32_bf16 v[112:115], v[164:167], v[144:147], v[112:115]
    v_mfma_f32_16x16x32_bf16 v[84:87], v[160:163], v[148:151], v[84:87]
    v_mfma_f32_16x16x32_bf16 v[116:119], v[164:167], v[148:151], v[116:119]
    v_mfma_f32_16x16x32_bf16 v[88:91], v[160:163], v[152:155], v[88:91]
    v_mfma_f32_16x16x32_bf16 v[120:123], v[164:167], v[152:155], v[120:123]
    v_mfma_f32_16x16x32_bf16 v[92:95], v[160:163], v[156:159], v[92:95]
    v_mfma_f32_16x16x32_bf16 v[124:127], v[164:167], v[156:159], v[124:127]
    s_nop 4
    v_lshrrev_b32 v60, 3, v1
    v_lshlrev_b32 v60, 11, v60
    v_bfe_u32 v61, v1, 4, 2
    v_lshlrev_b32 v61, 1, v61
    v_and_b32 v62, 7, v1
    v_xor_b32 v61, v61, v62
    v_lshlrev_b32 v61, 4, v61
    s_lshl_b32 s61, s89, 7
    v_add3_u32 v60, v60, v61, s61
    v_add_u32 v61, 15360, v60
    v_add_u32 v62, 30720, v60
    v_add_u32 v63, 46080, v60
    s_mov_b32 s32, s80
    s_mov_b32 s33, s81
    s_mov_b32 s34, 0x200000
    s_mov_b32 s35, 0x20000
    s_mov_b32 s36, s10
    s_mov_b32 s37, s11
    s_mov_b32 s38, 0x200000
    s_mov_b32 s39, 0x20000
    s_lshl_b32 s61, s41, 2
    s_add_u32 s61, s61, s49
    s_add_u32 s67, s61, 8
    s_and_b32 s61, s61, 31
    s_lshl_b32 s61, s61, 16
    s_and_b32 s67, s67, 31
    s_lshl_b32 s67, s67, 16
    s_lshl_b32 s68, s41, 15
    s_add_u32 s68, s68, 32768
    s_mov_b32 s63, 0
L_e_b1:
    ds_read_b32 v52, v6 offset:1024
    s_waitcnt lgkmcnt(0)
    v_cmp_gt_u32 vcc, 48, v52
    s_add_u32 s63, s63, 1
    s_cbranch_vccz L_e_b1ok
    s_cmp_lt_u32 s63, 1600000
    s_cbranch_scc1 L_e_b1
L_e_b1ok:

    v_pk_fma_f32 v[44:45], v[64:65], s[76:77], v[40:41] op_sel_hi:[1,1,0]
    v_pk_fma_f32 v[46:47], v[66:67], s[76:77], v[40:41] op_sel_hi:[1,1,0]
    v_pk_fma_f32 v[48:49], v[96:97], s[76:77], v[40:41] op_sel_hi:[1,1,0]
    v_pk_fma_f32 v[50:51], v[98:99], s[76:77], v[40:41] op_sel_hi:[1,1,0]
    s_add_u32 m0, s68, 0
    s_waitcnt vmcnt(8)
    buffer_load_dwordx4 v60, s[32:35], s61 offen offset:0 lds
    buffer_load_dwordx4 v61, s[32:35], s61 offen offset:1024 lds
    buffer_load_dwordx4 v62, s[32:35], s61 offen offset:2048 lds
    buffer_load_dwordx4 v63, s[32:35], s61 offen offset:3072 lds
    v_exp_f32 v44, v44 clamp
    v_max_f32 v64, s78, v64
    v_exp_f32 v45, v45 clamp
    v_max_f32 v65, s78, v65
    v_exp_f32 v46, v46 clamp
    v_max_f32 v66, s78, v66
    v_exp_f32 v47, v47 clamp
    v_max_f32 v67, s78, v67
    v_exp_f32 v48, v48 clamp
    v_max_f32 v96, s78, v96
    v_exp_f32 v49, v49 clamp
    v_max_f32 v97, s78, v97
    v_exp_f32 v50, v50 clamp
    v_max_f32 v98, s78, v98
    v_exp_f32 v51, v51 clamp
    v_max_f32 v99, s78, v99
    s_add_u32 m0, s68, 4096
    s_waitcnt vmcnt(8)
    buffer_load_dwordx4 v60, s[36:39], s61 offen offset:0 lds
    buffer_load_dwordx4 v61, s[36:39], s61 offen offset:1024 lds
    buffer_load_dwordx4 v62, s[36:39], s61 offen offset:2048 lds
    buffer_load_dwordx4 v63, s[36:39], s61 offen offset:3072 lds
    s_add_u32 s61, s61, 65536
    v_pk_add_f32 v[64:65], v[64:65], v[44:45]
    v_pk_add_f32 v[66:67], v[66:67], v[46:47]
    v_pk_add_f32 v[96:97], v[96:97], v[48:49]
    v_pk_add_f32 v[98:99], v[98:99], v[50:51]
    v_cvt_pk_bf16_f32 v64, v64, v65
    v_cvt_pk_bf16_f32 v65, v66, v67
    v_cvt_pk_bf16_f32 v66, v96, v97
    v_cvt_pk_bf16_f32 v67, v98, v99
    v_pk_fma_f32 v[52:53], v[68:69], s[76:77], v[40:41] op_sel_hi:[1,1,0]
    v_pk_fma_f32 v[54:55], v[70:71], s[76:77], v[40:41] op_sel_hi:[1,1,0]
    v_pk_fma_f32 v[56:57], v[100:101], s[76:77], v[40:41] op_sel_hi:[1,1,0]
    v_pk_fma_f32 v[58:59], v[102:103], s[76:77], v[40:41] op_sel_hi:[1,1,0]
    v_exp_f32 v52, v52 clamp
    v_max_f32 v68, s78, v68
    v_exp_f32 v53, v53 clamp
    v_max_f32 v69, s78, v69
    s_add_u32 m0, s68, 8192
    s_waitcnt vmcnt(8)
    buffer_load_dwordx4 v60, s[32:35], s61 offen offset:0 lds
    buffer_load_dwordx4 v61, s[32:35], s61 offen offset:1024 lds
    buffer_load_dwordx4 v62, s[32:35], s61 offen offset:2048 lds
    buffer_load_dwordx4 v63, s[32:35], s61 offen offset:3072 lds
    v_exp_f32 v54, v54 clamp
    v_max_f32 v70, s78, v70
    v_exp_f32 v55, v55 clamp
    v_max_f32 v71, s78, v71
    v_exp_f32 v56, v56 clamp
    v_max_f32 v100, s78, v100
    v_exp_f32 v57, v57 clamp
    v_max_f32 v101, s78, v101
    v_exp_f32 v58, v58 clamp
    v_max_f32 v102, s78, v102
    v_exp_f32 v59, v59 clamp
    v_max_f32 v103, s78, v103
    v_pk_add_f32 v[68:69], v[68:69], v[52:53]
    v_pk_add_f32 v[70:71], v[70:71], v[54:55]
    v_pk_add_f32 v[100:101], v[100:101], v[56:57]
    v_pk_add_f32 v[102:103], v[102:103], v[58:59]
    s_add_u32 m0, s68, 12288
    s_waitcnt vmcnt(8)
    buffer_load_dwordx4 v60, s[36:39], s61 offen offset:0 lds
    buffer_load_dwordx4 v61, s[36:39], s61 offen offset:1024 lds
    buffer_load_dwordx4 v62, s[36:39], s61 offen offset:2048 lds
    buffer_load_dwordx4 v63, s[36:39], s61 offen offset:3072 lds
    s_add_u32 s61, s61, 65536
    v_cvt_pk_bf16_f32 v68, v68, v69
    v_cvt_pk_bf16_f32 v69, v70, v71
    v_cvt_pk_bf16_f32 v70, v100, v101
    v_cvt_pk_bf16_f32 v71, v102, v103
    v_pk_fma_f32 v[44:45], v[72:73], s[76:77], v[40:41] op_sel_hi:[1,1,0]
    v_pk_fma_f32 v[46:47], v[74:75], s[76:77], v[40:41] op_sel_hi:[1,1,0]
    v_pk_fma_f32 v[48:49], v[104:105], s[76:77], v[40:41] op_sel_hi:[1,1,0]
    v_pk_fma_f32 v[50:51], v[106:107], s[76:77], v[40:41] op_sel_hi:[1,1,0]
    v_exp_f32 v44, v44 clamp
    v_max_f32 v72, s78, v72
    v_exp_f32 v45, v45 clamp
    v_max_f32 v73, s78, v73
    v_exp_f32 v46, v46 clamp
    v_max_f32 v74, s78, v74
    v_exp_f32 v47, v47 clamp
    v_max_f32 v75, s78, v75
    s_add_u32 m0, s68, 16384
    s_waitcnt vmcnt(8)
    buffer_load_dwordx4 v60, s[32:35], s61 offen offset:0 lds
    buffer_load_dwordx4 v61, s[32:35], s61 offen offset:1024 lds
    buffer_load_dwordx4 v62, s[32:35], s61 offen offset:2048 lds
    buffer_load_dwordx4 v63, s[32:35], s61 offen offset:3072 lds
    v_exp_f32 v48, v48 clamp
    v_max_f32 v104, s78, v104
    v_exp_f32 v49, v49 clamp
    v_max_f32 v105, s78, v105
    v_exp_f32 v50, v50 clamp
    v_max_f32 v106, s78, v106
    v_exp_f32 v51, v51 clamp
    v_max_f32 v107, s78, v107
    v_pk_add_f32 v[72:73], v[72:73], v[44:45]
    v_pk_add_f32 v[74:75], v[74:75], v[46:47]
    v_pk_add_f32 v[104:105], v[104:105], v[48:49]
    v_pk_add_f32 v[106:107], v[106:107], v[50:51]
    v_cvt_pk_bf16_f32 v72, v72, v73
    v_cvt_pk_bf16_f32 v73, v74, v75
    v_cvt_pk_bf16_f32 v74, v104, v105
    v_cvt_pk_bf16_f32 v75, v106, v107
    s_add_u32 m0, s68, 20480
    s_waitcnt vmcnt(8)
    buffer_load_dwordx4 v60, s[36:39], s61 offen offset:0 lds
    buffer_load_dwordx4 v61, s[36:39], s61 offen offset:1024 lds
    buffer_load_dwordx4 v62, s[36:39], s61 offen offset:2048 lds
    buffer_load_dwordx4 v63, s[36:39], s61 offen offset:3072 lds
    s_add_u32 s61, s61, 65536
    v_pk_fma_f32 v[52:53], v[76:77], s[76:77], v[40:41] op_sel_hi:[1,1,0]
    v_pk_fma_f32 v[54:55], v[78:79], s[76:77], v[40:41] op_sel_hi:[1,1,0]
    v_pk_fma_f32 v[56:57], v[108:109], s[76:77], v[40:41] op_sel_hi:[1,1,0]
    v_pk_fma_f32 v[58:59], v[110:111], s[76:77], v[40:41] op_sel_hi:[1,1,0]
    v_exp_f32 v52, v52 clamp
    v_max_f32 v76, s78, v76
    v_exp_f32 v53, v53 clamp
    v_max_f32 v77, s78, v77
    v_exp_f32 v54, v54 clamp
    v_max_f32 v78, s78, v78
    v_exp_f32 v55, v55 clamp
    v_max_f32 v79, s78, v79
    v_exp_f32 v56, v56 clamp
    v_max_f32 v108, s78, v108
    v_exp_f32 v57, v57 clamp
    v_max_f32 v109, s78, v109
    s_add_u32 m0, s68, 24576
    s_waitcnt vmcnt(8)
    buffer_load_dwordx4 v60, s[32:35], s61 offen offset:0 lds
    buffer_load_dwordx4 v61, s[32:35], s61 offen offset:1024 lds
    buffer_load_dwordx4 v62, s[32:35], s61 offen offset:2048 lds
    buffer_load_dwordx4 v63, s[32:35], s61 offen offset:3072 lds
    v_exp_f32 v58, v58 clamp
    v_max_f32 v110, s78, v110
    v_exp_f32 v59, v59 clamp
    v_max_f32 v111, s78, v111
    v_pk_add_f32 v[76:77], v[76:77], v[52:53]
    v_pk_add_f32 v[78:79], v[78:79], v[54:55]
    v_pk_add_f32 v[108:109], v[108:109], v[56:57]
    v_pk_add_f32 v[110:111], v[110:111], v[58:59]
    v_cvt_pk_bf16_f32 v76, v76, v77
    v_cvt_pk_bf16_f32 v77, v78, v79
    v_cvt_pk_bf16_f32 v78, v108, v109
    v_cvt_pk_bf16_f32 v79, v110, v111
    v_pk_fma_f32 v[44:45], v[80:81], s[76:77], v[40:41] op_sel_hi:[1,1,0]
    v_pk_fma_f32 v[46:47], v[82:83], s[76:77], v[40:41] op_sel_hi:[1,1,0]
    v_pk_fma_f32 v[48:49], v[112:113], s[76:77], v[40:41] op_sel_hi:[1,1,0]
    v_pk_fma_f32 v[50:51], v[114:115], s[76:77], v[40:41] op_sel_hi:[1,1,0]
    s_add_u32 m0, s68, 28672
    s_waitcnt vmcnt(8)
    buffer_load_dwordx4 v60, s[36:39], s61 offen offset:0 lds
    buffer_load_dwordx4 v61, s[36:39], s61 offen offset:1024 lds
    buffer_load_dwordx4 v62, s[36:39], s61 offen offset:2048 lds
    buffer_load_dwordx4 v63, s[36:39], s61 offen offset:3072 lds
    s_add_u32 s61, s61, 65536
    v_exp_f32 v44, v44 clamp
    v_max_f32 v80, s78, v80
    v_exp_f32 v45, v45 clamp
    v_max_f32 v81, s78, v81
    v_exp_f32 v46, v46 clamp
    v_max_f32 v82, s78, v82
    v_exp_f32 v47, v47 clamp
    v_max_f32 v83, s78, v83
    v_exp_f32 v48, v48 clamp
    v_max_f32 v112, s78, v112
    v_exp_f32 v49, v49 clamp
    v_max_f32 v113, s78, v113
    v_exp_f32 v50, v50 clamp
    v_max_f32 v114, s78, v114
    v_exp_f32 v51, v51 clamp
    v_max_f32 v115, s78, v115
    v_pk_add_f32 v[80:81], v[80:81], v[44:45]
    v_pk_add_f32 v[82:83], v[82:83], v[46:47]
    v_pk_add_f32 v[112:113], v[112:113], v[48:49]
    v_pk_add_f32 v[114:115], v[114:115], v[50:51]
    v_cvt_pk_bf16_f32 v80, v80, v81
    v_cvt_pk_bf16_f32 v81, v82, v83
    v_cvt_pk_bf16_f32 v82, v112, v113
    v_cvt_pk_bf16_f32 v83, v114, v115
    v_pk_fma_f32 v[52:53], v[84:85], s[76:77], v[40:41] op_sel_hi:[1,1,0]
    v_pk_fma_f32 v[54:55], v[86:87], s[76:77], v[40:41] op_sel_hi:[1,1,0]
    v_pk_fma_f32 v[56:57], v[116:117], s[76:77], v[40:41] op_sel_hi:[1,1,0]
    v_pk_fma_f32 v[58:59], v[118:119], s[76:77], v[40:41] op_sel_hi:[1,1,0]
    v_exp_f32 v52, v52 clamp
    v_max_f32 v84, s78, v84
    v_exp_f32 v53, v53 clamp
    v_max_f32 v85, s78, v85
    v_exp_f32 v54, v54 clamp
    v_max_f32 v86, s78, v86
    v_exp_f32 v55, v55 clamp
    v_max_f32 v87, s78, v87
    v_exp_f32 v56, v56 clamp
    v_max_f32 v116, s78, v116
    v_exp_f32 v57, v57 clamp
    v_max_f32 v117, s78, v117
    v_exp_f32 v58, v58 clamp
    v_max_f32 v118, s78, v118
    v_exp_f32 v59, v59 clamp
    v_max_f32 v119, s78, v119
    v_pk_add_f32 v[84:85], v[84:85], v[52:53]
    v_pk_add_f32 v[86:87], v[86:87], v[54:55]
    v_pk_add_f32 v[116:117], v[116:117], v[56:57]
    v_pk_add_f32 v[118:119], v[118:119], v[58:59]
    v_cvt_pk_bf16_f32 v84, v84, v85
    v_cvt_pk_bf16_f32 v85, v86, v87
    v_cvt_pk_bf16_f32 v86, v116, v117
    v_cvt_pk_bf16_f32 v87, v118, v119
    v_pk_fma_f32 v[44:45], v[88:89], s[76:77], v[40:41] op_sel_hi:[1,1,0]
    v_pk_fma_f32 v[46:47], v[90:91], s[76:77], v[40:41] op_sel_hi:[1,1,0]
    v_pk_fma_f32 v[48:49], v[120:121], s[76:77], v[40:41] op_sel_hi:[1,1,0]
    v_pk_fma_f32 v[50:51], v[122:123], s[76:77], v[40:41] op_sel_hi:[1,1,0]
    v_exp_f32 v44, v44 clamp
    v_max_f32 v88, s78, v88
    v_exp_f32 v45, v45 clamp
    v_max_f32 v89, s78, v89
    v_exp_f32 v46, v46 clamp
    v_max_f32 v90, s78, v90
    v_exp_f32 v47, v47 clamp
    v_max_f32 v91, s78, v91
    v_exp_f32 v48, v48 clamp
    v_max_f32 v120, s78, v120
    v_exp_f32 v49, v49 clamp
    v_max_f32 v121, s78, v121
    v_exp_f32 v50, v50 clamp
    v_max_f32 v122, s78, v122
    v_exp_f32 v51, v51 clamp
    v_max_f32 v123, s78, v123
    v_pk_add_f32 v[88:89], v[88:89], v[44:45]
    v_pk_add_f32 v[90:91], v[90:91], v[46:47]
    v_pk_add_f32 v[120:121], v[120:121], v[48:49]
    v_pk_add_f32 v[122:123], v[122:123], v[50:51]
    v_cvt_pk_bf16_f32 v88, v88, v89
    v_cvt_pk_bf16_f32 v89, v90, v91
    v_cvt_pk_bf16_f32 v90, v120, v121
    v_cvt_pk_bf16_f32 v91, v122, v123
    v_pk_fma_f32 v[52:53], v[92:93], s[76:77], v[40:41] op_sel_hi:[1,1,0]
    v_pk_fma_f32 v[54:55], v[94:95], s[76:77], v[40:41] op_sel_hi:[1,1,0]
    v_pk_fma_f32 v[56:57], v[124:125], s[76:77], v[40:41] op_sel_hi:[1,1,0]
    v_pk_fma_f32 v[58:59], v[126:127], s[76:77], v[40:41] op_sel_hi:[1,1,0]
    v_exp_f32 v52, v52 clamp
    v_max_f32 v92, s78, v92
    v_exp_f32 v53, v53 clamp
    v_max_f32 v93, s78, v93
    v_exp_f32 v54, v54 clamp
    v_max_f32 v94, s78, v94
    v_exp_f32 v55, v55 clamp
    v_max_f32 v95, s78, v95
    v_exp_f32 v56, v56 clamp
    v_max_f32 v124, s78, v124
    v_exp_f32 v57, v57 clamp
    v_max_f32 v125, s78, v125
    v_exp_f32 v58, v58 clamp
    v_max_f32 v126, s78, v126
    v_exp_f32 v59, v59 clamp
    v_max_f32 v127, s78, v127
    v_pk_add_f32 v[92:93], v[92:93], v[52:53]
    v_pk_add_f32 v[94:95], v[94:95], v[54:55]
    v_pk_add_f32 v[124:125], v[124:125], v[56:57]
    v_pk_add_f32 v[126:127], v[126:127], v[58:59]
    v_cvt_pk_bf16_f32 v92, v92, v93
    v_cvt_pk_bf16_f32 v93, v94, v95
    v_cvt_pk_bf16_f32 v94, v124, v125
    v_cvt_pk_bf16_f32 v95, v126, v127
    s_lshl_b32 s61, s41, 8
    s_mov_b32 m0, s61
    v_add_u32 v4, s74, v2
    v_mov_b32 v7, s58
    v_mov_b32 v6, 0
    s_mov_b32 s63, 0
L_e_ops:
    ds_read2_b32 v[8:9], v7 offset0:40 offset1:42
    ds_read_b128 v[36:39], v4 offset:2048
    ds_read_b128 v[28:31], v4
    ds_read_b128 v[32:35], v4 offset:1024
    ds_read_b32 v113, v6 offset:16
    s_waitcnt lgkmcnt(4)
    v_and_b32 v8, v8, v9
    v_cmp_eq_u32 vcc, 0, v8
    s_add_u32 s63, s63, 1
    s_waitcnt lgkmcnt(0)
    s_cbranch_vccz L_e_ops_ok
    s_cmp_lt_u32 s63, 1600000
    s_cbranch_scc1 L_e_ops
L_e_ops_ok:

    v_mfma_f32_16x16x32_bf16 v[136:139], v[36:39], v[64:67], 0
    v_mfma_f32_16x16x32_bf16 v[128:131], v[28:31], v[64:67], 0
    v_mfma_f32_16x16x32_bf16 v[132:135], v[32:35], v[64:67], 0
    v_mfma_f32_16x16x32_bf16 v[148:151], v[36:39], v[68:71], 0
    v_mfma_f32_16x16x32_bf16 v[140:143], v[28:31], v[68:71], 0
    v_mfma_f32_16x16x32_bf16 v[144:147], v[32:35], v[68:71], 0
    v_mfma_f32_16x16x32_bf16 v[160:163], v[36:39], v[72:75], 0
    v_mfma_f32_16x16x32_bf16 v[152:155], v[28:31], v[72:75], 0
    v_mfma_f32_16x16x32_bf16 v[156:159], v[32:35], v[72:75], 0
    v_readfirstlane_b32 s79, v113
    v_mov_b32 v114, 0
    v_add_f32 v136, s78, v136
    v_rcp_f32 v136, v136
    v_mfma_f32_16x16x32_bf16 v[172:175], v[36:39], v[76:79], 0
    v_pk_mul_f32 v[128:129], v[128:129], v[136:137] op_sel_hi:[1,0]
    v_pk_mul_f32 v[130:131], v[130:131], v[136:137] op_sel_hi:[1,0]
    v_pk_mul_f32 v[132:133], v[132:133], v[136:137] op_sel_hi:[1,0]
    v_pk_mul_f32 v[134:135], v[134:135], v[136:137] op_sel_hi:[1,0]
    v_mfma_f32_16x16x32_bf16 v[164:167], v[28:31], v[76:79], 0
    v_cvt_pk_bf16_f32 v224, v128, v129
    v_cvt_pk_bf16_f32 v225, v130, v131
    v_cvt_pk_bf16_f32 v226, v132, v133
    v_cvt_pk_bf16_f32 v227, v134, v135
    v_mfma_f32_16x16x32_bf16 v[168:171], v[32:35], v[76:79], 0
    buffer_store_dwordx4 v[224:227], v2, s[28:31], s64 offen offset:0 sc0 sc1
    v_add_f32 v148, s78, v148
    v_rcp_f32 v148, v148
    v_mfma_f32_16x16x32_bf16 v[184:187], v[36:39], v[80:83], 0
    v_pk_mul_f32 v[140:141], v[140:141], v[148:149] op_sel_hi:[1,0]
    v_pk_mul_f32 v[142:143], v[142:143], v[148:149] op_sel_hi:[1,0]
    v_pk_mul_f32 v[144:145], v[144:145], v[148:149] op_sel_hi:[1,0]
    v_pk_mul_f32 v[146:147], v[146:147], v[148:149] op_sel_hi:[1,0]
    v_mfma_f32_16x16x32_bf16 v[176:179], v[28:31], v[80:83], 0
    v_cvt_pk_bf16_f32 v228, v140, v141
    v_cvt_pk_bf16_f32 v229, v142, v143
    v_cvt_pk_bf16_f32 v230, v144, v145
    v_cvt_pk_bf16_f32 v231, v146, v147
    v_mfma_f32_16x16x32_bf16 v[180:183], v[32:35], v[80:83], 0
    buffer_store_dwordx4 v[228:231], v2, s[28:31], s64 offen offset:1024 sc0 sc1
    v_add_f32 v160, s78, v160
    v_rcp_f32 v160, v160
    v_mfma_f32_16x16x32_bf16 v[196:199], v[36:39], v[84:87], 0
    v_pk_mul_f32 v[152:153], v[152:153], v[160:161] op_sel_hi:[1,0]
    v_pk_mul_f32 v[154:155], v[154:155], v[160:161] op_sel_hi:[1,0]
    v_pk_mul_f32 v[156:157], v[156:157], v[160:161] op_sel_hi:[1,0]
    v_pk_mul_f32 v[158:159], v[158:159], v[160:161] op_sel_hi:[1,0]
    v_mfma_f32_16x16x32_bf16 v[188:191], v[28:31], v[84:87], 0
    v_cvt_pk_bf16_f32 v232, v152, v153
    v_cvt_pk_bf16_f32 v233, v154, v155
    v_cvt_pk_bf16_f32 v234, v156, v157
    v_cvt_pk_bf16_f32 v235, v158, v159
    v_mfma_f32_16x16x32_bf16 v[192:195], v[32:35], v[84:87], 0
    buffer_store_dwordx4 v[232:235], v2, s[28:31], s64 offen offset:2048 sc0 sc1
    v_add_f32 v172, s78, v172
    v_rcp_f32 v172, v172
    v_mfma_f32_16x16x32_bf16 v[208:211], v[36:39], v[88:91], 0
    v_pk_mul_f32 v[164:165], v[164:165], v[172:173] op_sel_hi:[1,0]
    v_pk_mul_f32 v[166:167], v[166:167], v[172:173] op_sel_hi:[1,0]
    v_pk_mul_f32 v[168:169], v[168:169], v[172:173] op_sel_hi:[1,0]
    v_pk_mul_f32 v[170:171], v[170:171], v[172:173] op_sel_hi:[1,0]
    v_mfma_f32_16x16x32_bf16 v[200:203], v[28:31], v[88:91], 0
    v_cvt_pk_bf16_f32 v236, v164, v165
    v_cvt_pk_bf16_f32 v237, v166, v167
    v_cvt_pk_bf16_f32 v238, v168, v169
    v_cvt_pk_bf16_f32 v239, v170, v171
    v_mfma_f32_16x16x32_bf16 v[204:207], v[32:35], v[88:91], 0
    buffer_store_dwordx4 v[236:239], v2, s[28:31], s64 offen offset:3072 sc0 sc1
    v_add_f32 v184, s78, v184
    v_rcp_f32 v184, v184
    v_mfma_f32_16x16x32_bf16 v[220:223], v[36:39], v[92:95], 0
    v_pk_mul_f32 v[176:177], v[176:177], v[184:185] op_sel_hi:[1,0]
    v_pk_mul_f32 v[178:179], v[178:179], v[184:185] op_sel_hi:[1,0]
    v_pk_mul_f32 v[180:181], v[180:181], v[184:185] op_sel_hi:[1,0]
    v_pk_mul_f32 v[182:183], v[182:183], v[184:185] op_sel_hi:[1,0]
    v_mfma_f32_16x16x32_bf16 v[212:215], v[28:31], v[92:95], 0
    v_cvt_pk_bf16_f32 v240, v176, v177
    v_cvt_pk_bf16_f32 v241, v178, v179
    v_cvt_pk_bf16_f32 v242, v180, v181
    v_cvt_pk_bf16_f32 v243, v182, v183
    v_mfma_f32_16x16x32_bf16 v[216:219], v[32:35], v[92:95], 0
    buffer_store_dwordx4 v[240:243], v2, s[28:31], s65 offen offset:0 sc0 sc1
    v_add_f32 v196, s78, v196
    v_rcp_f32 v196, v196
    s_nop 0
    v_pk_mul_f32 v[188:189], v[188:189], v[196:197] op_sel_hi:[1,0]
    v_pk_mul_f32 v[190:191], v[190:191], v[196:197] op_sel_hi:[1,0]
    v_pk_mul_f32 v[192:193], v[192:193], v[196:197] op_sel_hi:[1,0]
    v_pk_mul_f32 v[194:195], v[194:195], v[196:197] op_sel_hi:[1,0]
    v_cvt_pk_bf16_f32 v244, v188, v189
    v_cvt_pk_bf16_f32 v245, v190, v191
    v_cvt_pk_bf16_f32 v246, v192, v193
    v_cvt_pk_bf16_f32 v247, v194, v195
    buffer_store_dwordx4 v[244:247], v2, s[28:31], s65 offen offset:1024 sc0 sc1
    v_add_f32 v208, s78, v208
    v_rcp_f32 v208, v208
    s_nop 0
    v_pk_mul_f32 v[200:201], v[200:201], v[208:209] op_sel_hi:[1,0]
    v_pk_mul_f32 v[202:203], v[202:203], v[208:209] op_sel_hi:[1,0]
    v_pk_mul_f32 v[204:205], v[204:205], v[208:209] op_sel_hi:[1,0]
    v_pk_mul_f32 v[206:207], v[206:207], v[208:209] op_sel_hi:[1,0]
    v_cvt_pk_bf16_f32 v248, v200, v201
    v_cvt_pk_bf16_f32 v249, v202, v203
    v_cvt_pk_bf16_f32 v250, v204, v205
    v_cvt_pk_bf16_f32 v251, v206, v207
    buffer_store_dwordx4 v[248:251], v2, s[28:31], s65 offen offset:2048 sc0 sc1
    v_add_f32 v220, s78, v220
    v_rcp_f32 v220, v220
    s_nop 0
    v_pk_mul_f32 v[212:213], v[212:213], v[220:221] op_sel_hi:[1,0]
    v_pk_mul_f32 v[214:215], v[214:215], v[220:221] op_sel_hi:[1,0]
    v_pk_mul_f32 v[216:217], v[216:217], v[220:221] op_sel_hi:[1,0]
    v_pk_mul_f32 v[218:219], v[218:219], v[220:221] op_sel_hi:[1,0]
    v_cvt_pk_bf16_f32 v252, v212, v213
    v_cvt_pk_bf16_f32 v253, v214, v215
    v_cvt_pk_bf16_f32 v254, v216, v217
    v_cvt_pk_bf16_f32 v255, v218, v219
    buffer_store_dwordx4 v[252:255], v2, s[28:31], s65 offen offset:3072 sc0 sc1
    v_mov_b32 v115, 2
    ds_write_addtid_b32 v115 offset:3072
    s_lshl_b32 s60, s88, 1
    s_add_u32 s60, s60, s51
    s_lshl_b32 s52, s60, 1
    s_add_u32 s52, s52, s50
    s_lshl_b32 s52, s52, 17
    s_lshl_b32 s60, s60, 2
    s_lshl_b32 s53, s49, 12
    v_add_u32 v112, s49, v1
    v_and_b32 v112, 31, v112
    v_lshlrev_b32 v112, 4, v112
    s_lshl_b32 s54, s88, 10
    s_lshl_b32 s61, s50, 9
    s_add_u32 s54, s54, s61
    s_add_u32 s54, s54, 11534336
    s_mov_b32 s72, 0
    s_mov_b32 s73, 0
    s_mov_b32 s74, 0
    v_lshrrev_b32 v12, 4, v1
    v_lshrrev_b32 v13, 1, v12
    v_lshlrev_b32 v13, 10, v13
    v_and_b32 v12, 1, v12
    v_lshlrev_b32 v12, 2, v12
    v_bfe_u32 v14, v1, 2, 2
    v_add_u32 v12, v12, v14
    v_lshlrev_b32 v14, 7, v12
    v_add_u32 v13, v13, v14
    v_lshrrev_b32 v12, 1, v12
    v_lshlrev_b32 v12, 5, v12
    v_add_u32 v13, v13, v12
    v_and_b32 v12, 3, v1
    v_lshlrev_b32 v111, 8, v12
    v_lshlrev_b32 v12, 3, v12
    v_add_u32 v13, v13, v12
    s_lshl_b32 s61, s50, 12
    s_add_u32 s61, s61, 32768
    v_add_u32 v4, s61, v13
    v_xor_b32 v5, 32, v4
    v_xor_b32 v6, 64, v4
    v_xor_b32 v7, 96, v4
    v_mov_b32 v108, 32
    v_mov_b32 v3, 4
    s_lshl_b32 s59, s60, 10
    s_add_u32 s59, s59, 11796480
    s_mov_b32 s56, 0
    s_mov_b32 s70, 4294868992
    s_mov_b32 s71, 32768
    s_mov_b32 s32, s86
    s_mov_b32 s33, s87
    s_mov_b32 s34, 0x400000
    s_mov_b32 s35, 0x20000
    v_mov_b32 v115, 3
    s_lshl_b32 s61, s41, 2
    v_mov_b32 v109, s61
    v_mov_b32 v110, 4
    s_waitcnt vmcnt(0)
    s_mov_b64 exec, 1
    buffer_store_dword v113, v114, s[28:31], s69 offen sc0 sc1
    ds_add_u32 v109, v110 offset:32
    s_mov_b64 exec, -1
    ds_write_addtid_b32 v115 offset:3072

    s_lshl_b32 s61, s50, 2
    v_mov_b32 v112, s61
    v_mov_b32 v128, 0
    v_mov_b32 v129, 0
    v_mov_b32 v130, 0
    v_mov_b32 v131, 0
    v_mov_b32 v132, 0
    v_mov_b32 v133, 0
    v_mov_b32 v134, 0
    v_mov_b32 v135, 0
    v_mov_b32 v136, 0
    v_mov_b32 v137, 0
    v_mov_b32 v138, 0
    v_mov_b32 v139, 0
    v_mov_b32 v140, 0
    v_mov_b32 v141, 0
    v_mov_b32 v142, 0
    v_mov_b32 v143, 0
    v_mov_b32 v144, 0
    v_mov_b32 v145, 0
    v_mov_b32 v146, 0
    v_mov_b32 v147, 0
    v_mov_b32 v148, 0
    v_mov_b32 v149, 0
    v_mov_b32 v150, 0
    v_mov_b32 v151, 0
    v_mov_b32 v152, 0
    v_mov_b32 v153, 0
    v_mov_b32 v154, 0
    v_mov_b32 v155, 0
    v_mov_b32 v156, 0
    v_mov_b32 v157, 0
    v_mov_b32 v158, 0
    v_mov_b32 v159, 0
    v_mov_b32 v160, 0
    v_mov_b32 v161, 0
    v_mov_b32 v162, 0
    v_mov_b32 v163, 0
    v_mov_b32 v164, 0
    v_mov_b32 v165, 0
    v_mov_b32 v166, 0
    v_mov_b32 v167, 0
    v_mov_b32 v168, 0
    v_mov_b32 v169, 0
    v_mov_b32 v170, 0
    v_mov_b32 v171, 0
    v_mov_b32 v172, 0
    v_mov_b32 v173, 0
    v_mov_b32 v174, 0
    v_mov_b32 v175, 0
    v_mov_b32 v176, 0
    v_mov_b32 v177, 0
    v_mov_b32 v178, 0
    v_mov_b32 v179, 0
    v_mov_b32 v180, 0
    v_mov_b32 v181, 0
    v_mov_b32 v182, 0
    v_mov_b32 v183, 0
    v_mov_b32 v184, 0
    v_mov_b32 v185, 0
    v_mov_b32 v186, 0
    v_mov_b32 v187, 0
    v_mov_b32 v188, 0
    v_mov_b32 v189, 0
    v_mov_b32 v190, 0
    v_mov_b32 v191, 0
    s_lshl_b32 s62, s41, 13
    s_xor_b32 s63, s41, 2
    s_lshl_b32 s65, s63, 13
    v_add_u32 v118, s62, v2
    v_add_u32 v119, s65, v2
    s_lshl_b32 s63, s63, 8
    v_mov_b32 v120, s63
    v_and_b32 v121, 15, v1
    v_lshlrev_b32 v121, 11, v121
    v_bfe_u32 v122, v1, 4, 1
    v_lshlrev_b32 v122, 5, v122
    v_add_u32 v121, v121, v122
    v_lshrrev_b32 v122, 5, v1
    v_lshlrev_b32 v122, 4, v122
    v_add_u32 v121, v121, v122
    s_lshl_b32 s75, s60, 15
    s_lshl_b32 s63, s89, 7
    s_add_u32 s75, s75, s63
    s_lshl_b32 s63, s50, 6
    s_add_u32 s75, s75, s63
    s_add_u32 s76, s75, 32768
    s_add_u32 s77, s75, 65536
    s_add_u32 s78, s75, 98304
    v_mov_b32 v117, 4

L3_p0:
    ds_read_b32 v116, v112 offset:192
    s_waitcnt lgkmcnt(0)
    s_add_u32 s74, s74, 1
    v_readfirstlane_b32 s72, v116
    s_cmp_ge_u32 s74, 1600000
    s_cbranch_scc1 L3_p0_ok
    s_cmp_gt_u32 s72, s73
    s_cbranch_scc0 L3_p0
L3_p0_ok:

    s_add_u32 s55, s52, s53
    buffer_load_dwordx4 v[40:43], v2, s[28:31], s55 offen offset:0 sc1
    buffer_load_dwordx4 v[44:47], v2, s[28:31], s55 offen offset:1024 sc1
    buffer_load_dwordx4 v[48:51], v2, s[28:31], s55 offen offset:2048 sc1
    buffer_load_dwordx4 v[52:55], v2, s[28:31], s55 offen offset:3072 sc1
    s_add_u32 s53, s53, 4096
    s_and_b32 s53, s53, 0x1ffff
    s_add_u32 s73, s73, 1
    s_cmp_gt_u32 s72, s73
    s_cbranch_scc1 L3_p1_ok

L3_p1:
    ds_read_b32 v116, v112 offset:192
    s_waitcnt lgkmcnt(0)
    s_add_u32 s74, s74, 1
    v_readfirstlane_b32 s72, v116
    s_cmp_ge_u32 s74, 1600000
    s_cbranch_scc1 L3_p1_ok
    s_cmp_gt_u32 s72, s73
    s_cbranch_scc0 L3_p1
L3_p1_ok:

    s_add_u32 s55, s52, s53
    buffer_load_dwordx4 v[56:59], v2, s[28:31], s55 offen offset:0 sc1
    buffer_load_dwordx4 v[60:63], v2, s[28:31], s55 offen offset:1024 sc1
    buffer_load_dwordx4 v[64:67], v2, s[28:31], s55 offen offset:2048 sc1
    buffer_load_dwordx4 v[68:71], v2, s[28:31], s55 offen offset:3072 sc1
    s_add_u32 s53, s53, 4096
    s_and_b32 s53, s53, 0x1ffff
    s_add_u32 s73, s73, 1
    s_cmp_gt_u32 s72, s73
    s_cbranch_scc1 L3_p2_ok

L3_p2:
    ds_read_b32 v116, v112 offset:192
    s_waitcnt lgkmcnt(0)
    s_add_u32 s74, s74, 1
    v_readfirstlane_b32 s72, v116
    s_cmp_ge_u32 s74, 1600000
    s_cbranch_scc1 L3_p2_ok
    s_cmp_gt_u32 s72, s73
    s_cbranch_scc0 L3_p2
L3_p2_ok:

    s_add_u32 s55, s52, s53
    buffer_load_dwordx4 v[72:75], v2, s[28:31], s55 offen offset:0 sc1
    buffer_load_dwordx4 v[76:79], v2, s[28:31], s55 offen offset:1024 sc1
    buffer_load_dwordx4 v[80:83], v2, s[28:31], s55 offen offset:2048 sc1
    buffer_load_dwordx4 v[84:87], v2, s[28:31], s55 offen offset:3072 sc1
    s_add_u32 s53, s53, 4096
    s_and_b32 s53, s53, 0x1ffff
    s_add_u32 s73, s73, 1
    s_mov_b32 s63, 0
L3_w0:
    ds_read_b32 v0, v108
    s_waitcnt lgkmcnt(0)
    v_cmp_gt_u32 vcc, 4, v0
    s_add_u32 s63, s63, 1
    s_cbranch_vccz L3_w0_ok
    s_cmp_lt_u32 s63, 1600000
    s_cbranch_scc1 L3_w0
L3_w0_ok:

    ds_read_b64_tr_b16 v[8:9], v4 offset:0
    ds_read_b64_tr_b16 v[10:11], v4 offset:2048
    ds_read_b64_tr_b16 v[12:13], v5 offset:0
    ds_read_b64_tr_b16 v[14:15], v5 offset:2048
    ds_read_b64_tr_b16 v[16:17], v6 offset:0
    ds_read_b64_tr_b16 v[18:19], v6 offset:2048
    ds_read_b64_tr_b16 v[20:21], v7 offset:0
    ds_read_b64_tr_b16 v[22:23], v7 offset:2048
    v_add_u32 v108, 4, v108
    s_waitcnt lgkmcnt(0)
    s_add_u32 s55, s52, s53
    s_branch L3_loop
L3_sr0:
L3_sr0_p:
    ds_read_b32 v116, v112 offset:192
    s_waitcnt lgkmcnt(0)
    s_add_u32 s74, s74, 1
    v_readfirstlane_b32 s72, v116
    s_cmp_ge_u32 s74, 1600000
    s_cbranch_scc1 L3_sr0_p_ok
    s_cmp_gt_u32 s72, s73
    s_cbranch_scc0 L3_sr0_p
L3_sr0_p_ok:

    s_branch L3_sr0_ret
L3_sr1:
L3_sr1_p:
    ds_read_b32 v116, v112 offset:192
    s_waitcnt lgkmcnt(0)
    s_add_u32 s74, s74, 1
    v_readfirstlane_b32 s72, v116
    s_cmp_ge_u32 s74, 1600000
    s_cbranch_scc1 L3_sr1_p_ok
    s_cmp_gt_u32 s72, s73
    s_cbranch_scc0 L3_sr1_p
L3_sr1_p_ok:

    s_branch L3_sr1_ret
L3_sr2:
L3_sr2_p:
    ds_read_b32 v116, v112 offset:192
    s_waitcnt lgkmcnt(0)
    s_add_u32 s74, s74, 1
    v_readfirstlane_b32 s72, v116
    s_cmp_ge_u32 s74, 1600000
    s_cbranch_scc1 L3_sr2_p_ok
    s_cmp_gt_u32 s72, s73
    s_cbranch_scc0 L3_sr2_p
L3_sr2_p_ok:

    s_branch L3_sr2_ret
L3_sr3:
L3_sr3_p:
    ds_read_b32 v116, v112 offset:192
    s_waitcnt lgkmcnt(0)
    s_add_u32 s74, s74, 1
    v_readfirstlane_b32 s72, v116
    s_cmp_ge_u32 s74, 1600000
    s_cbranch_scc1 L3_sr3_p_ok
    s_cmp_gt_u32 s72, s73
    s_cbranch_scc0 L3_sr3_p
L3_sr3_p_ok:

    s_branch L3_sr3_ret
L3_sf:
    s_mov_b32 s63, 0
L3_sf_p:
    ds_read_b32 v0, v108
    s_waitcnt lgkmcnt(0)
    v_cmp_gt_u32 vcc, 4, v0
    s_add_u32 s63, s63, 1
    s_cbranch_vccz L3_sf_p_ok
    s_cmp_lt_u32 s63, 1600000
    s_cbranch_scc1 L3_sf_p
L3_sf_p_ok:

    s_branch L3_sf_ret
    .p2align 6
L3_loop:
    s_waitcnt vmcnt(8)
    s_waitcnt lgkmcnt(4)
    v_mfma_f32_16x16x32_bf16 v[128:131], v[8:11], v[40:43], v[128:131]
    ds_read_b64_tr_b16 v[24:25], v4 offset:8192
    s_cmp_gt_u32 s72, s73
    s_cbranch_scc0 L3_sr0
L3_sr0_ret:
    v_mfma_f32_16x16x32_bf16 v[132:135], v[8:11], v[44:47], v[132:135]
    buffer_load_dwordx4 v[88:91], v2, s[28:31], s55 offen offset:0 sc1
    v_mfma_f32_16x16x32_bf16 v[136:139], v[8:11], v[48:51], v[136:139]
    ds_read_b64_tr_b16 v[26:27], v4 offset:10240
    v_mfma_f32_16x16x32_bf16 v[140:143], v[8:11], v[52:55], v[140:143]
    ds_read_b64_tr_b16 v[28:29], v5 offset:8192
    v_mfma_f32_16x16x32_bf16 v[156:159], v[12:15], v[52:55], v[156:159]
    ds_read_b64_tr_b16 v[30:31], v5 offset:10240
    v_mfma_f32_16x16x32_bf16 v[152:155], v[12:15], v[48:51], v[152:155]
    buffer_load_dwordx4 v[92:95], v2, s[28:31], s55 offen offset:1024 sc1
    v_mfma_f32_16x16x32_bf16 v[148:151], v[12:15], v[44:47], v[148:151]
    ds_read_b64_tr_b16 v[32:33], v6 offset:8192
    v_mfma_f32_16x16x32_bf16 v[144:147], v[12:15], v[40:43], v[144:147]
    ds_read_b64_tr_b16 v[34:35], v6 offset:10240
    s_waitcnt lgkmcnt(6)
    v_mfma_f32_16x16x32_bf16 v[160:163], v[16:19], v[40:43], v[160:163]
    ds_read_b64_tr_b16 v[36:37], v7 offset:8192
    v_mfma_f32_16x16x32_bf16 v[164:167], v[16:19], v[44:47], v[164:167]
    ds_read_b64_tr_b16 v[38:39], v7 offset:10240
    v_mfma_f32_16x16x32_bf16 v[168:171], v[16:19], v[48:51], v[168:171]
    buffer_load_dwordx4 v[96:99], v2, s[28:31], s55 offen offset:2048 sc1
    v_mfma_f32_16x16x32_bf16 v[172:175], v[16:19], v[52:55], v[172:175]
    s_add_u32 s53, s53, 4096
    s_and_b32 s53, s53, 0x1ffff
    ds_read_b32 v0, v108
    v_mfma_f32_16x16x32_bf16 v[188:191], v[20:23], v[52:55], v[188:191]
    s_add_u32 s73, s73, 1
    v_mfma_f32_16x16x32_bf16 v[184:187], v[20:23], v[48:51], v[184:187]
    buffer_load_dwordx4 v[100:103], v2, s[28:31], s55 offen offset:3072 sc1
    v_mfma_f32_16x16x32_bf16 v[180:183], v[20:23], v[44:47], v[180:183]
    s_add_u32 s55, s52, s53
    v_mfma_f32_16x16x32_bf16 v[176:179], v[20:23], v[40:43], v[176:179]
    s_cmp_eq_u32 s73, 32
    s_cselect_b32 s55, s59, s55
    s_waitcnt vmcnt(8)
    s_waitcnt lgkmcnt(5)
    v_mfma_f32_16x16x32_bf16 v[128:131], v[24:27], v[56:59], v[128:131]
    ds_read_b64_tr_b16 v[8:9], v4 offset:16384
    s_cmp_gt_u32 s72, s73
    s_cbranch_scc0 L3_sr1
L3_sr1_ret:
    v_mfma_f32_16x16x32_bf16 v[132:135], v[24:27], v[60:63], v[132:135]
    buffer_load_dwordx4 v[40:43], v2, s[28:31], s55 offen offset:0 sc1
    v_mfma_f32_16x16x32_bf16 v[136:139], v[24:27], v[64:67], v[136:139]
    ds_read_b64_tr_b16 v[10:11], v4 offset:18432
    v_mfma_f32_16x16x32_bf16 v[140:143], v[24:27], v[68:71], v[140:143]
    ds_read_b64_tr_b16 v[12:13], v5 offset:16384
    v_mfma_f32_16x16x32_bf16 v[156:159], v[28:31], v[68:71], v[156:159]
    ds_read_b64_tr_b16 v[14:15], v5 offset:18432
    v_mfma_f32_16x16x32_bf16 v[152:155], v[28:31], v[64:67], v[152:155]
    buffer_load_dwordx4 v[44:47], v2, s[28:31], s55 offen offset:1024 sc1
    v_mfma_f32_16x16x32_bf16 v[148:151], v[28:31], v[60:63], v[148:151]
    ds_read_b64_tr_b16 v[16:17], v6 offset:16384
    v_mfma_f32_16x16x32_bf16 v[144:147], v[28:31], v[56:59], v[144:147]
    ds_read_b64_tr_b16 v[18:19], v6 offset:18432
    s_waitcnt lgkmcnt(6)
    v_mfma_f32_16x16x32_bf16 v[160:163], v[32:35], v[56:59], v[160:163]
    ds_read_b64_tr_b16 v[20:21], v7 offset:16384
    v_mfma_f32_16x16x32_bf16 v[164:167], v[32:35], v[60:63], v[164:167]
    ds_read_b64_tr_b16 v[22:23], v7 offset:18432
    v_mfma_f32_16x16x32_bf16 v[168:171], v[32:35], v[64:67], v[168:171]
    buffer_load_dwordx4 v[48:51], v2, s[28:31], s55 offen offset:2048 sc1
    v_mfma_f32_16x16x32_bf16 v[172:175], v[32:35], v[68:71], v[172:175]
    s_add_u32 s53, s53, 4096
    s_and_b32 s53, s53, 0x1ffff
    v_mfma_f32_16x16x32_bf16 v[188:191], v[36:39], v[68:71], v[188:191]
    s_add_u32 s73, s73, 1
    v_cmp_gt_u32 s[66:67], 4, v0
    v_mfma_f32_16x16x32_bf16 v[184:187], v[36:39], v[64:67], v[184:187]
    buffer_load_dwordx4 v[52:55], v2, s[28:31], s55 offen offset:3072 sc1
    v_mfma_f32_16x16x32_bf16 v[180:183], v[36:39], v[60:63], v[180:183]
    s_add_u32 s55, s52, s53
    s_add_u32 s56, s56, 4
    s_and_b32 s62, s56, 15
    v_mfma_f32_16x16x32_bf16 v[176:179], v[36:39], v[56:59], v[176:179]
    s_cselect_b32 s62, s71, s70
    s_waitcnt vmcnt(8)
    s_waitcnt lgkmcnt(4)
    v_mfma_f32_16x16x32_bf16 v[128:131], v[8:11], v[72:75], v[128:131]
    ds_read_b64_tr_b16 v[24:25], v4 offset:24576
    s_cmp_gt_u32 s72, s73
    s_cbranch_scc0 L3_sr2
L3_sr2_ret:
    v_mfma_f32_16x16x32_bf16 v[132:135], v[8:11], v[76:79], v[132:135]
    buffer_load_dwordx4 v[56:59], v2, s[28:31], s55 offen offset:0 sc1
    v_mfma_f32_16x16x32_bf16 v[136:139], v[8:11], v[80:83], v[136:139]
    ds_read_b64_tr_b16 v[26:27], v4 offset:26624
    v_mfma_f32_16x16x32_bf16 v[140:143], v[8:11], v[84:87], v[140:143]
    ds_read_b64_tr_b16 v[28:29], v5 offset:24576
    v_mfma_f32_16x16x32_bf16 v[156:159], v[12:15], v[84:87], v[156:159]
    ds_read_b64_tr_b16 v[30:31], v5 offset:26624
    v_mfma_f32_16x16x32_bf16 v[152:155], v[12:15], v[80:83], v[152:155]
    buffer_load_dwordx4 v[60:63], v2, s[28:31], s55 offen offset:1024 sc1
    v_mfma_f32_16x16x32_bf16 v[148:151], v[12:15], v[76:79], v[148:151]
    ds_read_b64_tr_b16 v[32:33], v6 offset:24576
    v_mfma_f32_16x16x32_bf16 v[144:147], v[12:15], v[72:75], v[144:147]
    ds_read_b64_tr_b16 v[34:35], v6 offset:26624
    s_waitcnt lgkmcnt(6)
    v_mfma_f32_16x16x32_bf16 v[160:163], v[16:19], v[72:75], v[160:163]
    ds_read_b64_tr_b16 v[36:37], v7 offset:24576
    v_mfma_f32_16x16x32_bf16 v[164:167], v[16:19], v[76:79], v[164:167]
    ds_read_b64_tr_b16 v[38:39], v7 offset:26624
    v_mfma_f32_16x16x32_bf16 v[168:171], v[16:19], v[80:83], v[168:171]
    buffer_load_dwordx4 v[64:67], v2, s[28:31], s55 offen offset:2048 sc1
    ds_write_addtid_b32 v3 offset:2048
    v_mfma_f32_16x16x32_bf16 v[172:175], v[16:19], v[84:87], v[172:175]
    s_add_u32 s53, s53, 4096
    s_and_b32 s53, s53, 0x1ffff
    v_add_u32 v4, s62, v4
    v_mfma_f32_16x16x32_bf16 v[188:191], v[20:23], v[84:87], v[188:191]
    s_add_u32 s73, s73, 1
    v_add_u32 v5, s62, v5
    v_mfma_f32_16x16x32_bf16 v[184:187], v[20:23], v[80:83], v[184:187]
    buffer_load_dwordx4 v[68:71], v2, s[28:31], s55 offen offset:3072 sc1
    v_add_u32 v6, s62, v6
    v_mfma_f32_16x16x32_bf16 v[180:183], v[20:23], v[76:79], v[180:183]
    s_add_u32 s55, s52, s53
    v_add_u32 v7, s62, v7
    v_mfma_f32_16x16x32_bf16 v[176:179], v[20:23], v[72:75], v[176:179]
    s_cmp_lg_u32 s66, 0
    s_cbranch_scc1 L3_sf
L3_sf_ret:
    s_waitcnt vmcnt(8)
    s_waitcnt lgkmcnt(5)
    v_mfma_f32_16x16x32_bf16 v[128:131], v[24:27], v[88:91], v[128:131]
    ds_read_b64_tr_b16 v[8:9], v4 offset:0
    s_cmp_gt_u32 s72, s73
    s_cbranch_scc0 L3_sr3
L3_sr3_ret:
    v_mfma_f32_16x16x32_bf16 v[132:135], v[24:27], v[92:95], v[132:135]
    buffer_load_dwordx4 v[72:75], v2, s[28:31], s55 offen offset:0 sc1
    v_mfma_f32_16x16x32_bf16 v[136:139], v[24:27], v[96:99], v[136:139]
    ds_read_b64_tr_b16 v[10:11], v4 offset:2048
    v_mfma_f32_16x16x32_bf16 v[140:143], v[24:27], v[100:103], v[140:143]
    ds_read_b64_tr_b16 v[12:13], v5 offset:0
    v_mfma_f32_16x16x32_bf16 v[156:159], v[28:31], v[100:103], v[156:159]
    ds_read_b64_tr_b16 v[14:15], v5 offset:2048
    v_mfma_f32_16x16x32_bf16 v[152:155], v[28:31], v[96:99], v[152:155]
    buffer_load_dwordx4 v[76:79], v2, s[28:31], s55 offen offset:1024 sc1
    v_mfma_f32_16x16x32_bf16 v[148:151], v[28:31], v[92:95], v[148:151]
    ds_read_b64_tr_b16 v[16:17], v6 offset:0
    v_mfma_f32_16x16x32_bf16 v[144:147], v[28:31], v[88:91], v[144:147]
    ds_read_b64_tr_b16 v[18:19], v6 offset:2048
    s_waitcnt lgkmcnt(7)
    v_mfma_f32_16x16x32_bf16 v[160:163], v[32:35], v[88:91], v[160:163]
    ds_read_b64_tr_b16 v[20:21], v7 offset:0
    v_mfma_f32_16x16x32_bf16 v[164:167], v[32:35], v[92:95], v[164:167]
    ds_read_b64_tr_b16 v[22:23], v7 offset:2048
    v_mfma_f32_16x16x32_bf16 v[168:171], v[32:35], v[96:99], v[168:171]
    buffer_load_dwordx4 v[80:83], v2, s[28:31], s55 offen offset:2048 sc1
    v_mfma_f32_16x16x32_bf16 v[172:175], v[32:35], v[100:103], v[172:175]
    s_add_u32 s53, s53, 4096
    s_and_b32 s53, s53, 0x1ffff
    v_add_u32 v3, 4, v3
    v_mfma_f32_16x16x32_bf16 v[188:191], v[36:39], v[100:103], v[188:191]
    s_add_u32 s73, s73, 1
    v_add_u32 v108, 4, v108
    v_mfma_f32_16x16x32_bf16 v[184:187], v[36:39], v[96:99], v[184:187]
    buffer_load_dwordx4 v[84:87], v2, s[28:31], s55 offen offset:3072 sc1
    v_mfma_f32_16x16x32_bf16 v[180:183], v[36:39], v[92:95], v[180:183]
    s_add_u32 s55, s52, s53
    v_mfma_f32_16x16x32_bf16 v[176:179], v[36:39], v[88:91], v[176:179]
    s_cmp_lt_u32 s56, 32
    s_cbranch_scc1 L3_loop
    ds_read_b32 v0, v111 offset:2048
    s_waitcnt vmcnt(8)
L3_gchk:
    v_xor_b32 v116, s79, v41
    v_bitop3_b32 v116, v116, v45, s79 bitop3:0xf6
    v_bitop3_b32 v116, v116, v49, s79 bitop3:0xf6
    v_bitop3_b32 v116, v116, v53, s79 bitop3:0xf6
    v_cmp_ne_u32 vcc, 0, v116
    s_cmp_eq_u32 s50, 0
    s_cbranch_vccnz L3_gslow
L3_gok:
    s_cbranch_scc0 L3_br1

    v_pk_mul_f32 v[160:161], v[160:161], v[40:41] op_sel_hi:[1,0]
    v_pk_mul_f32 v[162:163], v[162:163], v[40:41] op_sel_hi:[1,0]
    v_pk_mul_f32 v[164:165], v[164:165], v[44:45] op_sel_hi:[1,0]
    v_pk_mul_f32 v[166:167], v[166:167], v[44:45] op_sel_hi:[1,0]
    s_mov_b32 s63, 0
L3_b00:
    s_waitcnt lgkmcnt(0)
    v_cmp_gt_u32 vcc, 20, v0
    s_add_u32 s63, s63, 1
    s_cbranch_vccz L3_b0ok0
    s_cmp_ge_u32 s63, 1600000
    s_cbranch_scc1 L3_b0ok0
    ds_read_b32 v0, v111 offset:2048
    s_branch L3_b00
L3_b0ok0:

    ds_write_b128 v118, v[160:163] offset:32768
    v_pk_mul_f32 v[168:169], v[168:169], v[48:49] op_sel_hi:[1,0]
    v_pk_mul_f32 v[170:171], v[170:171], v[48:49] op_sel_hi:[1,0]
    ds_write_b128 v118, v[164:167] offset:34816
    v_pk_mul_f32 v[172:173], v[172:173], v[52:53] op_sel_hi:[1,0]
    v_pk_mul_f32 v[174:175], v[174:175], v[52:53] op_sel_hi:[1,0]
    ds_write_b128 v118, v[168:171] offset:36864
    v_pk_mul_f32 v[176:177], v[176:177], v[40:41] op_sel_hi:[1,0]
    v_pk_mul_f32 v[178:179], v[178:179], v[40:41] op_sel_hi:[1,0]
    ds_write_b128 v118, v[172:175] offset:38912
    v_pk_mul_f32 v[180:181], v[180:181], v[44:45] op_sel_hi:[1,0]
    v_pk_mul_f32 v[182:183], v[182:183], v[44:45] op_sel_hi:[1,0]
    ds_write_b128 v118, v[176:179] offset:33792
    v_pk_mul_f32 v[184:185], v[184:185], v[48:49] op_sel_hi:[1,0]
    v_pk_mul_f32 v[186:187], v[186:187], v[48:49] op_sel_hi:[1,0]
    ds_write_b128 v118, v[180:183] offset:35840
    v_pk_mul_f32 v[188:189], v[188:189], v[52:53] op_sel_hi:[1,0]
    v_pk_mul_f32 v[190:191], v[190:191], v[52:53] op_sel_hi:[1,0]
    ds_write_b128 v118, v[184:187] offset:37888
    ds_write_b128 v118, v[188:191] offset:39936
    ds_write_addtid_b32 v117 offset:3072
    s_mov_b32 s63, 0
L3_x0:
    ds_read_b32 v0, v120 offset:3072
    ds_read_b128 v[192:195], v119 offset:32768
    ds_read_b128 v[196:199], v119 offset:33792
    ds_read_b128 v[200:203], v119 offset:34816
    ds_read_b128 v[204:207], v119 offset:35840
    ds_read_b128 v[208:211], v119 offset:36864
    ds_read_b128 v[212:215], v119 offset:37888
    ds_read_b128 v[216:219], v119 offset:38912
    ds_read_b128 v[220:223], v119 offset:39936
    s_waitcnt lgkmcnt(8)
    v_cmp_gt_u32 vcc, 4, v0
    s_add_u32 s63, s63, 1
    s_cbranch_vccz L3_x0_ok
    s_waitcnt lgkmcnt(0)
    s_cmp_lt_u32 s63, 1600000
    s_cbranch_scc1 L3_x0
L3_x0_ok:

    s_waitcnt lgkmcnt(7)
    v_pk_fma_f32 v[192:193], v[128:129], v[40:41], v[192:193] op_sel_hi:[1,0,1]
    v_pk_fma_f32 v[194:195], v[130:131], v[40:41], v[194:195] op_sel_hi:[1,0,1]
    v_cvt_pk_bf16_f32 v8, v192, v193
    v_cvt_pk_bf16_f32 v9, v194, v195
    s_waitcnt lgkmcnt(6)
    v_pk_fma_f32 v[196:197], v[144:145], v[40:41], v[196:197] op_sel_hi:[1,0,1]
    v_pk_fma_f32 v[198:199], v[146:147], v[40:41], v[198:199] op_sel_hi:[1,0,1]
    v_cvt_pk_bf16_f32 v10, v196, v197
    v_cvt_pk_bf16_f32 v11, v198, v199
    s_waitcnt lgkmcnt(5)
    v_pk_fma_f32 v[200:201], v[132:133], v[44:45], v[200:201] op_sel_hi:[1,0,1]
    v_pk_fma_f32 v[202:203], v[134:135], v[44:45], v[202:203] op_sel_hi:[1,0,1]
    v_permlane16_swap_b32 v8, v10
    v_permlane16_swap_b32 v9, v11
    buffer_store_dwordx4 v[8:11], v121, s[32:35], s75 offen
    v_cvt_pk_bf16_f32 v12, v200, v201
    v_cvt_pk_bf16_f32 v13, v202, v203
    s_waitcnt lgkmcnt(4)
    v_pk_fma_f32 v[204:205], v[148:149], v[44:45], v[204:205] op_sel_hi:[1,0,1]
    v_pk_fma_f32 v[206:207], v[150:151], v[44:45], v[206:207] op_sel_hi:[1,0,1]
    v_cvt_pk_bf16_f32 v14, v204, v205
    v_cvt_pk_bf16_f32 v15, v206, v207
    s_waitcnt lgkmcnt(3)
    v_pk_fma_f32 v[208:209], v[136:137], v[48:49], v[208:209] op_sel_hi:[1,0,1]
    v_pk_fma_f32 v[210:211], v[138:139], v[48:49], v[210:211] op_sel_hi:[1,0,1]
    v_permlane16_swap_b32 v12, v14
    v_permlane16_swap_b32 v13, v15
    buffer_store_dwordx4 v[12:15], v121, s[32:35], s76 offen
    v_cvt_pk_bf16_f32 v16, v208, v209
    v_cvt_pk_bf16_f32 v17, v210, v211
    s_waitcnt lgkmcnt(2)
    v_pk_fma_f32 v[212:213], v[152:153], v[48:49], v[212:213] op_sel_hi:[1,0,1]
    v_pk_fma_f32 v[214:215], v[154:155], v[48:49], v[214:215] op_sel_hi:[1,0,1]
    v_cvt_pk_bf16_f32 v18, v212, v213
    v_cvt_pk_bf16_f32 v19, v214, v215
    s_waitcnt lgkmcnt(1)
    v_pk_fma_f32 v[216:217], v[140:141], v[52:53], v[216:217] op_sel_hi:[1,0,1]
    v_pk_fma_f32 v[218:219], v[142:143], v[52:53], v[218:219] op_sel_hi:[1,0,1]
    v_permlane16_swap_b32 v16, v18
    v_permlane16_swap_b32 v17, v19
    buffer_store_dwordx4 v[16:19], v121, s[32:35], s77 offen
    v_cvt_pk_bf16_f32 v20, v216, v217
    v_cvt_pk_bf16_f32 v21, v218, v219
    s_waitcnt lgkmcnt(0)
    v_pk_fma_f32 v[220:221], v[156:157], v[52:53], v[220:221] op_sel_hi:[1,0,1]
    v_pk_fma_f32 v[222:223], v[158:159], v[52:53], v[222:223] op_sel_hi:[1,0,1]
    v_cvt_pk_bf16_f32 v22, v220, v221
    v_cvt_pk_bf16_f32 v23, v222, v223
    s_nop 1
    v_permlane16_swap_b32 v20, v22
    v_permlane16_swap_b32 v21, v23
    buffer_store_dwordx4 v[20:23], v121, s[32:35], s78 offen
    s_endpgm
L3_gslow:
    s_add_u32 s74, s74, 8
    s_cmp_ge_u32 s74, 1600000
    s_cbranch_scc0 L3_gld
    s_cmp_eq_u32 s50, 0
    s_branch L3_gok
L3_gld:

    buffer_load_dwordx2 v[40:41], v2, s[28:31], s59 offen offset:0 sc1
    buffer_load_dwordx2 v[44:45], v2, s[28:31], s59 offen offset:1024 sc1
    buffer_load_dwordx2 v[48:49], v2, s[28:31], s59 offen offset:2048 sc1
    buffer_load_dwordx2 v[52:53], v2, s[28:31], s59 offen offset:3072 sc1
    s_waitcnt vmcnt(0)
    s_branch L3_gchk
L3_br1:
    v_sub_f32 v40, 1.0, v40
    v_sub_f32 v44, 1.0, v44
    v_sub_f32 v48, 1.0, v48
    v_sub_f32 v52, 1.0, v52
    v_pk_mul_f32 v[128:129], v[128:129], v[40:41] op_sel_hi:[1,0]
    v_pk_mul_f32 v[130:131], v[130:131], v[40:41] op_sel_hi:[1,0]
    v_pk_mul_f32 v[132:133], v[132:133], v[44:45] op_sel_hi:[1,0]
    v_pk_mul_f32 v[134:135], v[134:135], v[44:45] op_sel_hi:[1,0]
    s_mov_b32 s63, 0
L3_b01:
    s_waitcnt lgkmcnt(0)
    v_cmp_gt_u32 vcc, 20, v0
    s_add_u32 s63, s63, 1
    s_cbranch_vccz L3_b0ok1
    s_cmp_ge_u32 s63, 1600000
    s_cbranch_scc1 L3_b0ok1
    ds_read_b32 v0, v111 offset:2048
    s_branch L3_b01
L3_b0ok1:

    ds_write_b128 v118, v[128:131] offset:32768
    v_pk_mul_f32 v[136:137], v[136:137], v[48:49] op_sel_hi:[1,0]
    v_pk_mul_f32 v[138:139], v[138:139], v[48:49] op_sel_hi:[1,0]
    ds_write_b128 v118, v[132:135] offset:34816
    v_pk_mul_f32 v[140:141], v[140:141], v[52:53] op_sel_hi:[1,0]
    v_pk_mul_f32 v[142:143], v[142:143], v[52:53] op_sel_hi:[1,0]
    ds_write_b128 v118, v[136:139] offset:36864
    v_pk_mul_f32 v[144:145], v[144:145], v[40:41] op_sel_hi:[1,0]
    v_pk_mul_f32 v[146:147], v[146:147], v[40:41] op_sel_hi:[1,0]
    ds_write_b128 v118, v[140:143] offset:38912
    v_pk_mul_f32 v[148:149], v[148:149], v[44:45] op_sel_hi:[1,0]
    v_pk_mul_f32 v[150:151], v[150:151], v[44:45] op_sel_hi:[1,0]
    ds_write_b128 v118, v[144:147] offset:33792
    v_pk_mul_f32 v[152:153], v[152:153], v[48:49] op_sel_hi:[1,0]
    v_pk_mul_f32 v[154:155], v[154:155], v[48:49] op_sel_hi:[1,0]
    ds_write_b128 v118, v[148:151] offset:35840
    v_pk_mul_f32 v[156:157], v[156:157], v[52:53] op_sel_hi:[1,0]
    v_pk_mul_f32 v[158:159], v[158:159], v[52:53] op_sel_hi:[1,0]
    ds_write_b128 v118, v[152:155] offset:37888
    ds_write_b128 v118, v[156:159] offset:39936
    ds_write_addtid_b32 v117 offset:3072
    s_mov_b32 s63, 0
L3_x1:
    ds_read_b32 v0, v120 offset:3072
    ds_read_b128 v[192:195], v119 offset:32768
    ds_read_b128 v[196:199], v119 offset:33792
    ds_read_b128 v[200:203], v119 offset:34816
    ds_read_b128 v[204:207], v119 offset:35840
    ds_read_b128 v[208:211], v119 offset:36864
    ds_read_b128 v[212:215], v119 offset:37888
    ds_read_b128 v[216:219], v119 offset:38912
    ds_read_b128 v[220:223], v119 offset:39936
    s_waitcnt lgkmcnt(8)
    v_cmp_gt_u32 vcc, 4, v0
    s_add_u32 s63, s63, 1
    s_cbranch_vccz L3_x1_ok
    s_waitcnt lgkmcnt(0)
    s_cmp_lt_u32 s63, 1600000
    s_cbranch_scc1 L3_x1
L3_x1_ok:

    s_waitcnt lgkmcnt(7)
    v_pk_fma_f32 v[192:193], v[160:161], v[40:41], v[192:193] op_sel_hi:[1,0,1]
    v_pk_fma_f32 v[194:195], v[162:163], v[40:41], v[194:195] op_sel_hi:[1,0,1]
    v_cvt_pk_bf16_f32 v8, v192, v193
    v_cvt_pk_bf16_f32 v9, v194, v195
    s_waitcnt lgkmcnt(6)
    v_pk_fma_f32 v[196:197], v[176:177], v[40:41], v[196:197] op_sel_hi:[1,0,1]
    v_pk_fma_f32 v[198:199], v[178:179], v[40:41], v[198:199] op_sel_hi:[1,0,1]
    v_cvt_pk_bf16_f32 v10, v196, v197
    v_cvt_pk_bf16_f32 v11, v198, v199
    s_waitcnt lgkmcnt(5)
    v_pk_fma_f32 v[200:201], v[164:165], v[44:45], v[200:201] op_sel_hi:[1,0,1]
    v_pk_fma_f32 v[202:203], v[166:167], v[44:45], v[202:203] op_sel_hi:[1,0,1]
    v_permlane16_swap_b32 v8, v10
    v_permlane16_swap_b32 v9, v11
    buffer_store_dwordx4 v[8:11], v121, s[32:35], s75 offen
    v_cvt_pk_bf16_f32 v12, v200, v201
    v_cvt_pk_bf16_f32 v13, v202, v203
    s_waitcnt lgkmcnt(4)
    v_pk_fma_f32 v[204:205], v[180:181], v[44:45], v[204:205] op_sel_hi:[1,0,1]
    v_pk_fma_f32 v[206:207], v[182:183], v[44:45], v[206:207] op_sel_hi:[1,0,1]
    v_cvt_pk_bf16_f32 v14, v204, v205
    v_cvt_pk_bf16_f32 v15, v206, v207
    s_waitcnt lgkmcnt(3)
    v_pk_fma_f32 v[208:209], v[168:169], v[48:49], v[208:209] op_sel_hi:[1,0,1]
    v_pk_fma_f32 v[210:211], v[170:171], v[48:49], v[210:211] op_sel_hi:[1,0,1]
    v_permlane16_swap_b32 v12, v14
    v_permlane16_swap_b32 v13, v15
    buffer_store_dwordx4 v[12:15], v121, s[32:35], s76 offen
    v_cvt_pk_bf16_f32 v16, v208, v209
    v_cvt_pk_bf16_f32 v17, v210, v211
    s_waitcnt lgkmcnt(2)
    v_pk_fma_f32 v[212:213], v[184:185], v[48:49], v[212:213] op_sel_hi:[1,0,1]
    v_pk_fma_f32 v[214:215], v[186:187], v[48:49], v[214:215] op_sel_hi:[1,0,1]
    v_cvt_pk_bf16_f32 v18, v212, v213
    v_cvt_pk_bf16_f32 v19, v214, v215
    s_waitcnt lgkmcnt(1)
    v_pk_fma_f32 v[216:217], v[172:173], v[52:53], v[216:217] op_sel_hi:[1,0,1]
    v_pk_fma_f32 v[218:219], v[174:175], v[52:53], v[218:219] op_sel_hi:[1,0,1]
    v_permlane16_swap_b32 v16, v18
    v_permlane16_swap_b32 v17, v19
    buffer_store_dwordx4 v[16:19], v121, s[32:35], s77 offen
    v_cvt_pk_bf16_f32 v20, v216, v217
    v_cvt_pk_bf16_f32 v21, v218, v219
    s_waitcnt lgkmcnt(0)
    v_pk_fma_f32 v[220:221], v[188:189], v[52:53], v[220:221] op_sel_hi:[1,0,1]
    v_pk_fma_f32 v[222:223], v[190:191], v[52:53], v[222:223] op_sel_hi:[1,0,1]
    v_cvt_pk_bf16_f32 v22, v220, v221
    v_cvt_pk_bf16_f32 v23, v222, v223
    s_nop 1
    v_permlane16_swap_b32 v20, v22
    v_permlane16_swap_b32 v21, v23
    buffer_store_dwordx4 v[20:23], v121, s[32:35], s78 offen
    s_endpgm
L_up_s:
    v_mov_b32 v16, 0

    s_sub_u32 s50, s41, 4
    v_lshrrev_b32 v100, 3, v1
    v_lshlrev_b32 v100, 11, v100
    v_bfe_u32 v101, v1, 4, 2
    v_lshlrev_b32 v101, 1, v101
    v_and_b32 v102, 7, v1
    v_xor_b32 v101, v101, v102
    v_lshlrev_b32 v101, 4, v101
    s_lshl_b32 s76, s89, 7
    v_add3_u32 v116, v100, v101, s76
    v_add_u32 v117, 16384, v116
    v_add_u32 v118, 32768, v116
    v_add_u32 v119, 49152, v116
    s_mov_b32 s32, s80
    s_mov_b32 s33, s81
    s_mov_b32 s34, 0x200000
    s_mov_b32 s35, 0x20000
    s_mov_b32 s36, s10
    s_mov_b32 s37, s11
    s_mov_b32 s38, 0x200000
    s_mov_b32 s39, 0x20000
    s_lshl_b32 s74, s50, 2
    s_add_u32 s74, s74, s49
    s_add_u32 s75, s74, 16
    s_and_b32 s74, s74, 31
    s_lshl_b32 s74, s74, 16

    s_and_b32 s75, s75, 31
    s_lshl_b32 s75, s75, 16
    v_lshlrev_b32 v2, 4, v1
    s_lshl_b32 s76, s50, 15
    s_add_u32 s76, s76, 32768
    v_add_u32 v120, s76, v2
    s_and_b32 s77, s50, 1
    s_lshr_b32 s78, s50, 1
    s_lshl_b32 s76, s44, 1
    s_add_u32 s76, s76, s77
    s_lshl_b32 s76, s76, 1
    s_add_u32 s76, s76, s78
    s_mul_i32 s69, s76, 24576
    s_add_u32 s69, s69, 8388608
    s_mul_i32 s68, s45, 3072
    s_add_u32 s68, s68, s69
    s_mul_i32 s70, s77, 5120
    s_add_u32 s70, s70, 4096
    s_lshl_b32 s76, s78, 11
    s_add_u32 s76, s76, s70
    v_add_u32 v121, s76, v2
    s_lshl_b32 s76, s78, 8
    s_add_u32 s76, s76, s70
    s_add_u32 s76, s76, 4096
    v_lshlrev_b32 v100, 2, v1
    v_add_u32 v122, s76, v100
    s_lshl_b32 s76, s77, 8
    v_mov_b32 v123, s76
    s_mul_i32 s76, s77, 3072
    s_lshl_b32 s70, s78, 3
    s_add_u32 s76, s76, s70
    s_add_u32 s76, s76, 24576
    v_add_u32 v124, s76, v2
    s_lshl_b32 s76, s50, 2
    v_mov_b32 v125, s76
    v_lshrrev_b32 v103, 5, v1
    v_lshlrev_b32 v103, 11, v103
    v_and_b32 v100, 31, v1
    v_lshlrev_b32 v100, 4, v100
    s_and_b32 s76, s40, 3
    s_lshl_b32 s76, s76, 9
    v_add3_u32 v103, v103, v100, s76
    s_and_b32 s95, s42, 7
    s_add_u32 s95, s95, 4
    s_mul_i32 s95, s95, 3
    s_add_u32 s95, s95, 2

    v_and_b32 v3, 7, v1
    v_lshlrev_b32 v3, 3, v3
    s_getreg_b32 s63, hwreg(HW_REG_XCC_ID, 0, 4)
    s_lshl_b32 s64, s44, 7
    s_add_u32 s64, s64, 11730944
    s_lshl_b32 s65, s45, 3
    s_add_u32 s65, s65, s64
    v_mov_b32 v9, s63

    s_cmp_eq_u32 s41, 7
    s_cbranch_scc0 L_nocw
    s_lshl_b32 s60, s42, 10
    s_add_u32 s60, s60, 0
    s_cmp_gt_u32 s60, L_end - gated_mix__linear_attn_block__linear_attn_block__prompt_kernel - 1024
    s_cbranch_scc1 L_nocw

    s_mov_b32 s66, 0
L_cw_w:
    ds_read_b32 v17, v16 offset:0
    s_waitcnt lgkmcnt(0)
    v_cmp_gt_u32 vcc, 40, v17
    s_add_u32 s66, s66, 1
    s_cbranch_vccz L_cw_w_ok
    s_sleep 8
    s_cmp_lt_u32 s66, 1600000
    s_cbranch_scc1 L_cw_w
L_cw_w_ok:

    s_getpc_b64 s[62:63]
L_cw_pc:
    s_sub_u32 s62, s62, L_cw_pc - gated_mix__linear_attn_block__linear_attn_block__prompt_kernel
    s_subb_u32 s63, s63, 0
    v_add_u32 v4, s60, v2
    global_load_dwordx4 v[8:11], v4, s[62:63]
    s_waitcnt vmcnt(0)
L_nocw:

    s_cmp_eq_u32 s41, 5
    s_cbranch_scc0 L_hold

    s_mov_b32 s66, 0
L_tag_w:
    ds_read_b32 v17, v16 offset:0
    s_waitcnt lgkmcnt(0)
    v_cmp_gt_u32 vcc, 9, v17
    s_add_u32 s66, s66, 1
    s_cbranch_vccz L_tag_w_ok
    s_sleep 16
    s_cmp_lt_u32 s66, 1600000
    s_cbranch_scc1 L_tag_w
L_tag_w_ok:

    s_mov_b32 s66, 0
L_tag_poll:
    global_load_dword v8, v16, s[12:13] sc0 sc1
    s_waitcnt vmcnt(0)
    v_cmp_eq_u32 vcc, 0, v8
    s_add_u32 s66, s66, 1
    s_cbranch_vccz L_tag_ok
    s_sleep 8
    s_cmp_lt_u32 s66, 1600000
    s_cbranch_scc1 L_tag_poll
L_tag_ok:
    s_mov_b64 exec, 1
    buffer_store_dwordx2 v[8:9], v16, s[28:31], s65 offen sc0 sc1
    s_mov_b64 exec, -1

    s_mov_b32 s66, 0
L_xcc_w:
    ds_read_b32 v17, v16 offset:0
    s_waitcnt lgkmcnt(0)
    v_cmp_gt_u32 vcc, 15, v17
    s_add_u32 s66, s66, 1
    s_cbranch_vccz L_xcc_w_ok
    s_sleep 16
    s_cmp_lt_u32 s66, 1600000
    s_cbranch_scc1 L_xcc_w
L_xcc_w_ok:

    s_mov_b32 s66, 0
L_xcc_poll:
    buffer_load_dwordx2 v[10:11], v3, s[28:31], s64 offen sc0 sc1
    s_waitcnt vmcnt(0)
    v_cmp_ne_u32 vcc, v8, v10
    s_add_u32 s66, s66, 1
    s_cbranch_vccz L_xcc_ok
    s_sleep 8
    s_cmp_lt_u32 s66, 1600000
    s_cbranch_scc1 L_xcc_poll
L_xcc_ok:
    v_cmp_ne_u32 vcc, v9, v11
    s_mov_b32 s62, 1
    s_cbranch_vccz L_xcc_same
    s_mov_b32 s62, 2
L_xcc_same:
    v_mov_b32 v9, s62
    ds_write_b64 v16, v[8:9] offset:16
L_hold:

    s_and_b32 s60, s89, 7
    s_lshl_b32 s60, s60, 7
    s_and_b32 s61, s50, 1
    s_lshl_b32 s61, s61, 15
    s_add_u32 s61, s61, 384
    s_sub_u32 s61, s61, s60
    v_add_u32 v12, s61, v116
    v_add_u32 v13, 16384, v12
    s_lshl_b32 s67, s42, 16

    s_mov_b32 s66, 0
L_bad_w:
    ds_read_b32 v17, v16 offset:0
    s_waitcnt lgkmcnt(0)
    v_cmp_gt_u32 vcc, 47, v17
    s_add_u32 s66, s66, 1
    s_cbranch_vccz L_bad_w_ok
    s_sleep 4
    s_cmp_lt_u32 s66, 1600000
    s_cbranch_scc1 L_bad_w
L_bad_w_ok:

    s_cmp_lt_u32 s50, 2
    s_cselect_b32 s92, s80, s10
    s_cselect_b32 s93, s81, s11
    s_mov_b32 s94, 0x200000
    s_mov_b32 s95, 0x20000
    buffer_load_dwordx4 v[8:11], v12, s[92:95], s67 offen
    buffer_load_dwordx4 v[8:11], v13, s[92:95], s67 offen

    s_mov_b32 s66, 0
L_hold_w:
    ds_read_b32 v17, v16 offset:0
    s_waitcnt lgkmcnt(0)
    v_cmp_gt_u32 vcc, 48, v17
    s_add_u32 s66, s66, 1
    s_cbranch_vccz L_hold_w_ok
    s_sleep 4
    s_cmp_lt_u32 s66, 1600000
    s_cbranch_scc1 L_hold_w
L_hold_w_ok:

    buffer_load_dwordx4 v[8:11], v2, s[28:31], s68 offen offset:0
    buffer_load_dwordx4 v[8:11], v2, s[28:31], s68 offen offset:1024
    buffer_load_dwordx4 v[8:11], v2, s[28:31], s68 offen offset:2048
    buffer_load_dwordx4 v[128:131], v116, s[32:35], s75 offen
    buffer_load_dwordx4 v[132:135], v117, s[32:35], s75 offen
    buffer_load_dwordx4 v[136:139], v118, s[32:35], s75 offen
    buffer_load_dwordx4 v[140:143], v119, s[32:35], s75 offen
    s_waitcnt vmcnt(8)
    buffer_load_dwordx4 v[144:147], v116, s[36:39], s75 offen
    buffer_load_dwordx4 v[148:151], v117, s[36:39], s75 offen
    buffer_load_dwordx4 v[152:155], v118, s[36:39], s75 offen
    buffer_load_dwordx4 v[156:159], v119, s[36:39], s75 offen
    s_add_u32 s75, s75, 65536
    s_waitcnt vmcnt(8)
    buffer_load_dwordx4 v[160:163], v116, s[32:35], s75 offen
    buffer_load_dwordx4 v[164:167], v117, s[32:35], s75 offen
    buffer_load_dwordx4 v[168:171], v118, s[32:35], s75 offen
    buffer_load_dwordx4 v[172:175], v119, s[32:35], s75 offen
    s_waitcnt vmcnt(8)
    buffer_load_dwordx4 v[176:179], v116, s[36:39], s75 offen
    buffer_load_dwordx4 v[180:183], v117, s[36:39], s75 offen
    buffer_load_dwordx4 v[184:187], v118, s[36:39], s75 offen
    buffer_load_dwordx4 v[188:191], v119, s[36:39], s75 offen
    s_add_u32 s75, s75, 65536
    s_waitcnt vmcnt(8)
    buffer_load_dwordx4 v[192:195], v116, s[32:35], s75 offen
    buffer_load_dwordx4 v[196:199], v117, s[32:35], s75 offen
    buffer_load_dwordx4 v[200:203], v118, s[32:35], s75 offen
    buffer_load_dwordx4 v[204:207], v119, s[32:35], s75 offen
    s_waitcnt vmcnt(8)
    buffer_load_dwordx4 v[208:211], v116, s[36:39], s75 offen
    buffer_load_dwordx4 v[212:215], v117, s[36:39], s75 offen
    buffer_load_dwordx4 v[216:219], v118, s[36:39], s75 offen
    buffer_load_dwordx4 v[220:223], v119, s[36:39], s75 offen
    s_add_u32 s75, s75, 65536
    s_waitcnt vmcnt(8)
    buffer_load_dwordx4 v[224:227], v116, s[32:35], s75 offen
    buffer_load_dwordx4 v[228:231], v117, s[32:35], s75 offen
    buffer_load_dwordx4 v[232:235], v118, s[32:35], s75 offen
    buffer_load_dwordx4 v[236:239], v119, s[32:35], s75 offen
    s_waitcnt vmcnt(8)
    buffer_load_dwordx4 v[240:243], v116, s[36:39], s75 offen
    buffer_load_dwordx4 v[244:247], v117, s[36:39], s75 offen
    buffer_load_dwordx4 v[248:251], v118, s[36:39], s75 offen
    buffer_load_dwordx4 v[252:255], v119, s[36:39], s75 offen
    s_add_u32 s75, s75, 65536
    s_waitcnt vmcnt(8)
    s_setprio 3
    v_and_b32 v3, 3, v1
    v_lshlrev_b32 v18, 8, v3
    v_mov_b32 v19, 7

    s_mov_b32 s63, 0
L_hold_tag:
    ds_read_b32 v17, v16 offset:16
    ds_read_b32 v12, v16 offset:20
    s_waitcnt lgkmcnt(0)
    s_add_u32 s63, s63, 1
    v_readfirstlane_b32 s56, v17
    s_cmp_ge_u32 s63, 1600000
    s_cbranch_scc1 L_hold_tag_ok
    s_cmp_ge_u32 s56, 1
    s_cbranch_scc0 L_hold_tag
L_hold_tag_ok:

    s_mov_b32 s79, s56
    v_readfirstlane_b32 s65, v12
    v_mov_b32 v23, s56
    v_mov_b32 v27, s56
    v_mov_b32 v31, s56

    s_mul_i32 s67, s50, 3
    s_mov_b32 s67, 46
    s_mov_b32 s66, 0
L_up_p:
    ds_read_b32 v17, v18 offset:1024
    s_waitcnt lgkmcnt(0)
    v_cmp_gt_u32 vcc, s67, v17
    s_add_u32 s66, s66, 1
    s_cbranch_vccz L_up_pok
    s_sleep 2
    s_cmp_lt_u32 s66, 1600000
    s_cbranch_scc1 L_up_p
L_up_pok:

    s_setprio 3
    s_mov_b32 s63, 0
L_k_w:
    ds_read2st64_b32 v[12:13], v123 offset0:12 offset1:14
    s_waitcnt lgkmcnt(0)
    v_and_b32 v12, v12, v13
    v_cmp_eq_u32 vcc, 0, v12
    s_add_u32 s63, s63, 1
    s_cbranch_vccz L_k_ok
    s_cmp_lt_u32 s63, 1600000
    s_cbranch_scc1 L_k_w
L_k_ok:
    ds_read_b128 v[32:35], v121
    ds_read_b128 v[40:43], v121 offset:10240
    ds_read_b128 v[36:39], v121 offset:1024
    ds_read_b128 v[44:47], v121 offset:11264
    ds_read_b32 v48, v122
    ds_read_b32 v49, v122 offset:10240
    s_cmp_eq_u32 s65, 1
    s_waitcnt lgkmcnt(4)

    v_add_f32 v20, v32, v40
    v_add_f32 v21, v33, v41
    v_add_f32 v22, v34, v42
    v_add_f32 v24, v35, v43
    s_waitcnt lgkmcnt(2)
    v_add_f32 v25, v36, v44
    v_add_f32 v26, v37, v45
    v_add_f32 v28, v38, v46
    v_add_f32 v29, v39, v47
    s_waitcnt lgkmcnt(0)
    v_add_f32 v30, v48, v49
    s_cbranch_scc1 L_e_stl
    buffer_store_dwordx4 v[20:23], v2, s[28:31], s68 offen sc0 sc1
    buffer_store_dwordx4 v[24:27], v2, s[28:31], s68 offen offset:1024 sc0 sc1
    buffer_store_dwordx4 v[28:31], v2, s[28:31], s68 offen offset:2048 sc0 sc1
    s_branch L_e_std
L_e_stl:
    buffer_store_dwordx4 v[20:23], v2, s[28:31], s68 offen
    buffer_store_dwordx4 v[24:27], v2, s[28:31], s68 offen offset:1024
    buffer_store_dwordx4 v[28:31], v2, s[28:31], s68 offen offset:2048
L_e_std:

    s_add_u32 s72, s45, 1
    s_and_b32 s72, s72, 7
    s_mul_i32 s72, s72, 3072
    s_add_u32 s72, s72, s69
    buffer_load_dwordx4 v[32:35], v2, s[28:31], s72 offen offset:0 sc1
    buffer_load_dwordx4 v[36:39], v2, s[28:31], s72 offen offset:1024 sc1
    buffer_load_dwordx4 v[40:43], v2, s[28:31], s72 offen offset:2048 sc1
    s_add_u32 s72, s45, 2
    s_and_b32 s72, s72, 7
    s_mul_i32 s72, s72, 3072
    s_add_u32 s72, s72, s69
    buffer_load_dwordx4 v[44:47], v2, s[28:31], s72 offen offset:0 sc1
    buffer_load_dwordx4 v[48:51], v2, s[28:31], s72 offen offset:1024 sc1
    buffer_load_dwordx4 v[52:55], v2, s[28:31], s72 offen offset:2048 sc1
    s_add_u32 s72, s45, 3
    s_and_b32 s72, s72, 7
    s_mul_i32 s72, s72, 3072
    s_add_u32 s72, s72, s69
    buffer_load_dwordx4 v[56:59], v2, s[28:31], s72 offen offset:0 sc1
    buffer_load_dwordx4 v[60:63], v2, s[28:31], s72 offen offset:1024 sc1
    buffer_load_dwordx4 v[64:67], v2, s[28:31], s72 offen offset:2048 sc1
    s_add_u32 s72, s45, 4
    s_and_b32 s72, s72, 7
    s_mul_i32 s72, s72, 3072
    s_add_u32 s72, s72, s69
    buffer_load_dwordx4 v[68:71], v2, s[28:31], s72 offen offset:0 sc1
    buffer_load_dwordx4 v[72:75], v2, s[28:31], s72 offen offset:1024 sc1
    buffer_load_dwordx4 v[76:79], v2, s[28:31], s72 offen offset:2048 sc1
    s_add_u32 s72, s45, 5
    s_and_b32 s72, s72, 7
    s_mul_i32 s72, s72, 3072
    s_add_u32 s72, s72, s69
    buffer_load_dwordx4 v[80:83], v2, s[28:31], s72 offen offset:0 sc1
    buffer_load_dwordx4 v[84:87], v2, s[28:31], s72 offen offset:1024 sc1
    buffer_load_dwordx4 v[88:91], v2, s[28:31], s72 offen offset:2048 sc1
    s_add_u32 s72, s45, 6
    s_and_b32 s72, s72, 7
    s_mul_i32 s72, s72, 3072
    s_add_u32 s72, s72, s69
    buffer_load_dwordx4 v[92:95], v2, s[28:31], s72 offen offset:0 sc1
    buffer_load_dwordx4 v[96:99], v2, s[28:31], s72 offen offset:1024 sc1
    buffer_load_dwordx4 v[100:103], v2, s[28:31], s72 offen offset:2048 sc1
    s_add_u32 s72, s45, 7
    s_and_b32 s72, s72, 7
    s_mul_i32 s72, s72, 3072
    s_add_u32 s72, s72, s69
    buffer_load_dwordx4 v[104:107], v2, s[28:31], s72 offen offset:0 sc1
    buffer_load_dwordx4 v[108:111], v2, s[28:31], s72 offen offset:1024 sc1
    buffer_load_dwordx4 v[112:115], v2, s[28:31], s72 offen offset:2048 sc1
    v_mov_b32 v3, 0
    s_mov_b32 s71, 0
    s_waitcnt vmcnt(18)
    v_pk_add_f32 v[4:5], v[20:21], v[32:33]
    v_pk_add_f32 v[6:7], v[22:23], v[34:35]
    v_bitop3_b32 v3, v3, v35, s79 bitop3:0xf6
    v_pk_add_f32 v[8:9], v[24:25], v[36:37]
    v_pk_add_f32 v[10:11], v[26:27], v[38:39]
    v_bitop3_b32 v3, v3, v39, s79 bitop3:0xf6
    v_pk_add_f32 v[12:13], v[28:29], v[40:41]
    v_pk_add_f32 v[14:15], v[30:31], v[42:43]
    v_bitop3_b32 v3, v3, v43, s79 bitop3:0xf6
    s_waitcnt vmcnt(15)
    v_pk_add_f32 v[4:5], v[4:5], v[44:45]
    v_pk_add_f32 v[6:7], v[6:7], v[46:47]
    v_bitop3_b32 v3, v3, v47, s79 bitop3:0xf6
    v_pk_add_f32 v[8:9], v[8:9], v[48:49]
    v_pk_add_f32 v[10:11], v[10:11], v[50:51]
    v_bitop3_b32 v3, v3, v51, s79 bitop3:0xf6
    v_pk_add_f32 v[12:13], v[12:13], v[52:53]
    v_pk_add_f32 v[14:15], v[14:15], v[54:55]
    v_bitop3_b32 v3, v3, v55, s79 bitop3:0xf6
    s_waitcnt vmcnt(12)
    v_pk_add_f32 v[4:5], v[4:5], v[56:57]
    v_pk_add_f32 v[6:7], v[6:7], v[58:59]
    v_bitop3_b32 v3, v3, v59, s79 bitop3:0xf6
    v_pk_add_f32 v[8:9], v[8:9], v[60:61]
    v_pk_add_f32 v[10:11], v[10:11], v[62:63]
    v_bitop3_b32 v3, v3, v63, s79 bitop3:0xf6
    v_pk_add_f32 v[12:13], v[12:13], v[64:65]
    v_pk_add_f32 v[14:15], v[14:15], v[66:67]
    v_bitop3_b32 v3, v3, v67, s79 bitop3:0xf6
    s_waitcnt vmcnt(9)
    v_pk_add_f32 v[4:5], v[4:5], v[68:69]
    v_pk_add_f32 v[6:7], v[6:7], v[70:71]
    v_bitop3_b32 v3, v3, v71, s79 bitop3:0xf6
    v_pk_add_f32 v[8:9], v[8:9], v[72:73]
    v_pk_add_f32 v[10:11], v[10:11], v[74:75]
    v_bitop3_b32 v3, v3, v75, s79 bitop3:0xf6
    v_pk_add_f32 v[12:13], v[12:13], v[76:77]
    v_pk_add_f32 v[14:15], v[14:15], v[78:79]
    v_bitop3_b32 v3, v3, v79, s79 bitop3:0xf6
    s_waitcnt vmcnt(6)
    v_pk_add_f32 v[4:5], v[4:5], v[80:81]
    v_pk_add_f32 v[6:7], v[6:7], v[82:83]
    v_bitop3_b32 v3, v3, v83, s79 bitop3:0xf6
    v_pk_add_f32 v[8:9], v[8:9], v[84:85]
    v_pk_add_f32 v[10:11], v[10:11], v[86:87]
    v_bitop3_b32 v3, v3, v87, s79 bitop3:0xf6
    v_pk_add_f32 v[12:13], v[12:13], v[88:89]
    v_pk_add_f32 v[14:15], v[14:15], v[90:91]
    v_bitop3_b32 v3, v3, v91, s79 bitop3:0xf6
    s_waitcnt vmcnt(3)
    v_pk_add_f32 v[4:5], v[4:5], v[92:93]
    v_pk_add_f32 v[6:7], v[6:7], v[94:95]
    v_bitop3_b32 v3, v3, v95, s79 bitop3:0xf6
    v_pk_add_f32 v[8:9], v[8:9], v[96:97]
    v_pk_add_f32 v[10:11], v[10:11], v[98:99]
    v_bitop3_b32 v3, v3, v99, s79 bitop3:0xf6
    v_pk_add_f32 v[12:13], v[12:13], v[100:101]
    v_pk_add_f32 v[14:15], v[14:15], v[102:103]
    v_bitop3_b32 v3, v3, v103, s79 bitop3:0xf6
    s_waitcnt vmcnt(0)
    v_pk_add_f32 v[4:5], v[4:5], v[104:105]
    v_pk_add_f32 v[6:7], v[6:7], v[106:107]
    v_bitop3_b32 v3, v3, v107, s79 bitop3:0xf6
    v_pk_add_f32 v[8:9], v[8:9], v[108:109]
    v_pk_add_f32 v[10:11], v[10:11], v[110:111]
    v_bitop3_b32 v3, v3, v111, s79 bitop3:0xf6
    v_pk_add_f32 v[12:13], v[12:13], v[112:113]
    v_pk_add_f32 v[14:15], v[14:15], v[114:115]
    v_bitop3_b32 v3, v3, v115, s79 bitop3:0xf6
    v_cmp_ne_u32 vcc, 0, v3
    s_cbranch_vccz L_g_all
    s_mov_b32 s70, 1
L_g_round:
    s_waitcnt vmcnt(0)

    s_bitcmp1_b32 s70, 1
    s_cbranch_scc1 L_g_s1
    v_xor_b32 v3, s79, v35
    v_bitop3_b32 v3, v3, v39, s79 bitop3:0xf6
    v_bitop3_b32 v3, v3, v43, s79 bitop3:0xf6
    v_cmp_ne_u32 vcc, 0, v3
    s_bitset1_b32 s70, 1
    s_cbranch_vccz L_g_s1
    s_bitset0_b32 s70, 1

    s_add_u32 s72, s45, 1
    s_and_b32 s72, s72, 7
    s_mul_i32 s72, s72, 3072
    s_add_u32 s72, s72, s69
    buffer_load_dwordx4 v[32:35], v2, s[28:31], s72 offen offset:0 sc1
    buffer_load_dwordx4 v[36:39], v2, s[28:31], s72 offen offset:1024 sc1
    buffer_load_dwordx4 v[40:43], v2, s[28:31], s72 offen offset:2048 sc1
L_g_s1:
    s_bitcmp1_b32 s70, 2
    s_cbranch_scc1 L_g_s2
    v_xor_b32 v3, s79, v47
    v_bitop3_b32 v3, v3, v51, s79 bitop3:0xf6
    v_bitop3_b32 v3, v3, v55, s79 bitop3:0xf6
    v_cmp_ne_u32 vcc, 0, v3
    s_bitset1_b32 s70, 2
    s_cbranch_vccz L_g_s2
    s_bitset0_b32 s70, 2

    s_add_u32 s72, s45, 2
    s_and_b32 s72, s72, 7
    s_mul_i32 s72, s72, 3072
    s_add_u32 s72, s72, s69
    buffer_load_dwordx4 v[44:47], v2, s[28:31], s72 offen offset:0 sc1
    buffer_load_dwordx4 v[48:51], v2, s[28:31], s72 offen offset:1024 sc1
    buffer_load_dwordx4 v[52:55], v2, s[28:31], s72 offen offset:2048 sc1
L_g_s2:
    s_bitcmp1_b32 s70, 3
    s_cbranch_scc1 L_g_s3
    v_xor_b32 v3, s79, v59
    v_bitop3_b32 v3, v3, v63, s79 bitop3:0xf6
    v_bitop3_b32 v3, v3, v67, s79 bitop3:0xf6
    v_cmp_ne_u32 vcc, 0, v3
    s_bitset1_b32 s70, 3
    s_cbranch_vccz L_g_s3
    s_bitset0_b32 s70, 3

    s_add_u32 s72, s45, 3
    s_and_b32 s72, s72, 7
    s_mul_i32 s72, s72, 3072
    s_add_u32 s72, s72, s69
    buffer_load_dwordx4 v[56:59], v2, s[28:31], s72 offen offset:0 sc1
    buffer_load_dwordx4 v[60:63], v2, s[28:31], s72 offen offset:1024 sc1
    buffer_load_dwordx4 v[64:67], v2, s[28:31], s72 offen offset:2048 sc1
L_g_s3:
    s_bitcmp1_b32 s70, 4
    s_cbranch_scc1 L_g_s4
    v_xor_b32 v3, s79, v71
    v_bitop3_b32 v3, v3, v75, s79 bitop3:0xf6
    v_bitop3_b32 v3, v3, v79, s79 bitop3:0xf6
    v_cmp_ne_u32 vcc, 0, v3
    s_bitset1_b32 s70, 4
    s_cbranch_vccz L_g_s4
    s_bitset0_b32 s70, 4

    s_add_u32 s72, s45, 4
    s_and_b32 s72, s72, 7
    s_mul_i32 s72, s72, 3072
    s_add_u32 s72, s72, s69
    buffer_load_dwordx4 v[68:71], v2, s[28:31], s72 offen offset:0 sc1
    buffer_load_dwordx4 v[72:75], v2, s[28:31], s72 offen offset:1024 sc1
    buffer_load_dwordx4 v[76:79], v2, s[28:31], s72 offen offset:2048 sc1
L_g_s4:
    s_bitcmp1_b32 s70, 5
    s_cbranch_scc1 L_g_s5
    v_xor_b32 v3, s79, v83
    v_bitop3_b32 v3, v3, v87, s79 bitop3:0xf6
    v_bitop3_b32 v3, v3, v91, s79 bitop3:0xf6
    v_cmp_ne_u32 vcc, 0, v3
    s_bitset1_b32 s70, 5
    s_cbranch_vccz L_g_s5
    s_bitset0_b32 s70, 5

    s_add_u32 s72, s45, 5
    s_and_b32 s72, s72, 7
    s_mul_i32 s72, s72, 3072
    s_add_u32 s72, s72, s69
    buffer_load_dwordx4 v[80:83], v2, s[28:31], s72 offen offset:0 sc1
    buffer_load_dwordx4 v[84:87], v2, s[28:31], s72 offen offset:1024 sc1
    buffer_load_dwordx4 v[88:91], v2, s[28:31], s72 offen offset:2048 sc1
L_g_s5:
    s_bitcmp1_b32 s70, 6
    s_cbranch_scc1 L_g_s6
    v_xor_b32 v3, s79, v95
    v_bitop3_b32 v3, v3, v99, s79 bitop3:0xf6
    v_bitop3_b32 v3, v3, v103, s79 bitop3:0xf6
    v_cmp_ne_u32 vcc, 0, v3
    s_bitset1_b32 s70, 6
    s_cbranch_vccz L_g_s6
    s_bitset0_b32 s70, 6

    s_add_u32 s72, s45, 6
    s_and_b32 s72, s72, 7
    s_mul_i32 s72, s72, 3072
    s_add_u32 s72, s72, s69
    buffer_load_dwordx4 v[92:95], v2, s[28:31], s72 offen offset:0 sc1
    buffer_load_dwordx4 v[96:99], v2, s[28:31], s72 offen offset:1024 sc1
    buffer_load_dwordx4 v[100:103], v2, s[28:31], s72 offen offset:2048 sc1
L_g_s6:
    s_bitcmp1_b32 s70, 7
    s_cbranch_scc1 L_g_s7
    v_xor_b32 v3, s79, v107
    v_bitop3_b32 v3, v3, v111, s79 bitop3:0xf6
    v_bitop3_b32 v3, v3, v115, s79 bitop3:0xf6
    v_cmp_ne_u32 vcc, 0, v3
    s_bitset1_b32 s70, 7
    s_cbranch_vccz L_g_s7
    s_bitset0_b32 s70, 7

    s_add_u32 s72, s45, 7
    s_and_b32 s72, s72, 7
    s_mul_i32 s72, s72, 3072
    s_add_u32 s72, s72, s69
    buffer_load_dwordx4 v[104:107], v2, s[28:31], s72 offen offset:0 sc1
    buffer_load_dwordx4 v[108:111], v2, s[28:31], s72 offen offset:1024 sc1
    buffer_load_dwordx4 v[112:115], v2, s[28:31], s72 offen offset:2048 sc1
L_g_s7:
    s_add_u32 s71, s71, 1
    s_cmp_ge_u32 s71, 200000
    s_cbranch_scc1 L_g_done
    s_cmp_eq_u32 s70, 255
    s_cbranch_scc0 L_g_round
L_g_done:

    v_pk_add_f32 v[4:5], v[20:21], v[32:33]
    v_pk_add_f32 v[6:7], v[22:23], v[34:35]
    v_pk_add_f32 v[8:9], v[24:25], v[36:37]
    v_pk_add_f32 v[10:11], v[26:27], v[38:39]
    v_pk_add_f32 v[12:13], v[28:29], v[40:41]
    v_pk_add_f32 v[14:15], v[30:31], v[42:43]
    v_pk_add_f32 v[4:5], v[4:5], v[44:45]
    v_pk_add_f32 v[6:7], v[6:7], v[46:47]
    v_pk_add_f32 v[8:9], v[8:9], v[48:49]
    v_pk_add_f32 v[10:11], v[10:11], v[50:51]
    v_pk_add_f32 v[12:13], v[12:13], v[52:53]
    v_pk_add_f32 v[14:15], v[14:15], v[54:55]
    v_pk_add_f32 v[4:5], v[4:5], v[56:57]
    v_pk_add_f32 v[6:7], v[6:7], v[58:59]
    v_pk_add_f32 v[8:9], v[8:9], v[60:61]
    v_pk_add_f32 v[10:11], v[10:11], v[62:63]
    v_pk_add_f32 v[12:13], v[12:13], v[64:65]
    v_pk_add_f32 v[14:15], v[14:15], v[66:67]
    v_pk_add_f32 v[4:5], v[4:5], v[68:69]
    v_pk_add_f32 v[6:7], v[6:7], v[70:71]
    v_pk_add_f32 v[8:9], v[8:9], v[72:73]
    v_pk_add_f32 v[10:11], v[10:11], v[74:75]
    v_pk_add_f32 v[12:13], v[12:13], v[76:77]
    v_pk_add_f32 v[14:15], v[14:15], v[78:79]
    v_pk_add_f32 v[4:5], v[4:5], v[80:81]
    v_pk_add_f32 v[6:7], v[6:7], v[82:83]
    v_pk_add_f32 v[8:9], v[8:9], v[84:85]
    v_pk_add_f32 v[10:11], v[10:11], v[86:87]
    v_pk_add_f32 v[12:13], v[12:13], v[88:89]
    v_pk_add_f32 v[14:15], v[14:15], v[90:91]
    v_pk_add_f32 v[4:5], v[4:5], v[92:93]
    v_pk_add_f32 v[6:7], v[6:7], v[94:95]
    v_pk_add_f32 v[8:9], v[8:9], v[96:97]
    v_pk_add_f32 v[10:11], v[10:11], v[98:99]
    v_pk_add_f32 v[12:13], v[12:13], v[100:101]
    v_pk_add_f32 v[14:15], v[14:15], v[102:103]
    v_pk_add_f32 v[4:5], v[4:5], v[104:105]
    v_pk_add_f32 v[6:7], v[6:7], v[106:107]
    v_pk_add_f32 v[8:9], v[8:9], v[108:109]
    v_pk_add_f32 v[10:11], v[10:11], v[110:111]
    v_pk_add_f32 v[12:13], v[12:13], v[112:113]
    v_pk_add_f32 v[14:15], v[14:15], v[114:115]
L_g_all:
    v_cvt_pk_bf16_f32 v20, v4, v5
    v_cvt_pk_bf16_f32 v21, v6, v8
    v_cvt_pk_bf16_f32 v22, v9, v10
    v_cvt_pk_bf16_f32 v23, v12, v13
    ds_write_b64 v124, v[20:21]
    v_mov_b32_dpp v24, v14 quad_perm:[0,0,0,0] row_mask:0xf bank_mask:0xf
    v_mov_b32_dpp v25, v14 quad_perm:[1,1,1,1] row_mask:0xf bank_mask:0xf
    ds_write_b64 v124, v[22:23] offset:1024
    v_mov_b32_dpp v26, v14 quad_perm:[2,2,2,2] row_mask:0xf bank_mask:0xf
    v_mov_b32_dpp v27, v14 quad_perm:[3,3,3,3] row_mask:0xf bank_mask:0xf
    v_cvt_pk_bf16_f32 v24, v24, v25
    v_cvt_pk_bf16_f32 v25, v26, v27
    ds_write_b64 v124, v[24:25] offset:2048
    ds_write_b32 v125, v19 offset:160

    s_setprio 0

    s_lshl_b32 s83, s45, 8
    s_lshl_b32 s61, s44, 3
    s_add_u32 s83, s83, s61
    s_lshl_b32 s61, s50, 1
    s_add_u32 s83, s83, s61
    s_lshl_b32 s61, s83, 11
    global_load_dwordx4 v[64:67], v2, s[84:85]
    global_load_dwordx4 v[68:71], v2, s[84:85] offset:1024
    buffer_load_dwordx4 v[72:75], v2, s[20:23], s61 offen
    buffer_load_dwordx4 v[76:79], v2, s[20:23], s61 offen offset:1024
    buffer_load_dwordx4 v[80:83], v2, s[20:23], s61 offen offset:2048
    buffer_load_dwordx4 v[84:87], v2, s[20:23], s61 offen offset:3072

    ds_write_b32 v16, v19 offset:64

    v_mov_b32 v88, 0
    v_mov_b32 v90, 0
    s_waitcnt vmcnt(0)

    v_dot2c_f32_bf16 v88, v72, v64
    v_dot2c_f32_bf16 v90, v80, v64
    v_dot2c_f32_bf16 v88, v73, v65
    v_dot2c_f32_bf16 v90, v81, v65
    v_dot2c_f32_bf16 v88, v74, v66
    v_dot2c_f32_bf16 v90, v82, v66
    v_dot2c_f32_bf16 v88, v75, v67
    v_dot2c_f32_bf16 v90, v83, v67
    v_dot2c_f32_bf16 v88, v76, v68
    v_dot2c_f32_bf16 v90, v84, v68
    v_dot2c_f32_bf16 v88, v77, v69
    v_dot2c_f32_bf16 v90, v85, v69
    v_dot2c_f32_bf16 v88, v78, v70
    v_dot2c_f32_bf16 v90, v86, v70
    v_dot2c_f32_bf16 v88, v79, v71
    v_dot2c_f32_bf16 v90, v87, v71
    s_waitcnt lgkmcnt(0)
    s_nop 3
    v_add_f32_dpp v88, v88, v88 row_shr:1 row_mask:0xf bank_mask:0xf
    v_add_f32_dpp v90, v90, v90 row_shr:1 row_mask:0xf bank_mask:0xf
    s_nop 0
    v_add_f32_dpp v88, v88, v88 row_shr:2 row_mask:0xf bank_mask:0xf
    v_add_f32_dpp v90, v90, v90 row_shr:2 row_mask:0xf bank_mask:0xf
    s_nop 0
    v_add_f32_dpp v88, v88, v88 row_shr:4 row_mask:0xf bank_mask:0xf
    v_add_f32_dpp v90, v90, v90 row_shr:4 row_mask:0xf bank_mask:0xf
    s_nop 0
    v_add_f32_dpp v88, v88, v88 row_shr:8 row_mask:0xf bank_mask:0xf
    v_add_f32_dpp v90, v90, v90 row_shr:8 row_mask:0xf bank_mask:0xf
    s_nop 0
    v_add_f32_dpp v88, v88, v88 row_bcast:15 row_mask:0xa bank_mask:0xf
    v_add_f32_dpp v90, v90, v90 row_bcast:15 row_mask:0xa bank_mask:0xf
    s_nop 0
    v_add_f32_dpp v88, v88, v88 row_bcast:31 row_mask:0xc bank_mask:0xf
    v_add_f32_dpp v90, v90, v90 row_bcast:31 row_mask:0xc bank_mask:0xf
    s_nop 0
    v_readlane_b32 s60, v88, 63
    v_readlane_b32 s61, v90, 63
    v_cmp_gt_u32 vcc, 4, v1
    v_mov_b32 v88, s60
    v_mov_b32 v90, s61
    v_cndmask_b32 v88, v90, v88, vcc
    v_mul_f32 v88, 0xbfb8aa3b, v88
    v_exp_f32 v88, v88
    v_and_b32 v91, 3, v1
    v_add_f32 v88, 1.0, v88
    v_rcp_f32 v88, v88
    v_lshlrev_b32 v91, 8, v91
    v_bfe_u32 v92, v1, 2, 1
    v_lshlrev_b32 v92, 4, v92
    v_add_u32 v91, v91, v92
    v_mov_b32 v89, s79
    s_lshr_b32 s60, s83, 4
    s_lshl_b32 s60, s60, 10
    s_and_b32 s61, s83, 15
    s_lshl_b32 s61, s61, 4
    s_add_u32 s60, s60, s61
    s_add_u32 s60, s60, 11796480
    s_mov_b64 exec, 0xff
    buffer_store_dwordx2 v[88:89], v91, s[28:31], s60 offen sc0 sc1
    s_mov_b64 exec, -1

    s_cmp_eq_u32 s50, 3
    s_cbranch_scc0 L_nopoll
    s_setprio 2
    v_add_u32 v4, s49, v1
    v_and_b32 v4, 31, v4
    v_and_b32 v5, 32, v1
    v_or_b32 v4, v4, v5
    v_lshlrev_b32 v4, 4, v4
    s_lshl_b32 s60, s88, 10
    s_add_u32 s60, s60, 11534336
    s_mov_b32 s63, 0
L_pu_s:
    ds_read_b32 v17, v18 offset:3072
    s_waitcnt lgkmcnt(0)
    v_cmp_gt_u32 vcc, 3, v17
    s_add_u32 s63, s63, 1
    s_cbranch_vccz L_pu_l
    s_sleep 1
    s_cmp_lt_u32 s63, 1600000
    s_cbranch_scc1 L_pu_s
L_pu_l:
    buffer_load_dword v5, v4, s[28:31], s60 offen sc1
    s_waitcnt vmcnt(0)
    v_cmp_eq_u32 vcc, s79, v5
    s_add_u32 s63, s63, 8
    s_ff0_i32_b32 s61, vcc_lo
    s_ff0_i32_b32 s62, vcc_hi
    v_mov_b32 v6, s61
    v_mov_b32 v7, s62
    ds_write_b64 v16, v[6:7] offset:192
    s_and_b32 s61, s61, s62
    s_cmp_eq_u32 s61, -1
    s_cbranch_scc1 L_nopoll
    s_sleep 3
    s_cmp_lt_u32 s63, 1600000
    s_cbranch_scc1 L_pu_l
L_nopoll:
    s_setprio 0

    s_lshl_b32 s61, s50, 2
    s_add_u32 s61, s61, 4
    s_mov_b32 s63, 0
L_duty_w:
    s_sleep 4
    ds_read_b32 v17, v18 offset:2048
    s_waitcnt lgkmcnt(0)
    v_cmp_gt_u32 vcc, s61, v17
    s_add_u32 s63, s63, 1
    s_cbranch_vccz L_duty_go
    s_cmp_lt_u32 s63, 1600000
    s_cbranch_scc1 L_duty_w
L_duty_go:
    s_waitcnt vmcnt(0)

    ds_write_b128 v120, v[128:131] offset:0
    ds_write_b128 v120, v[132:135] offset:1024
    ds_write_b128 v120, v[136:139] offset:2048
    ds_write_b128 v120, v[140:143] offset:3072
    s_waitcnt lgkmcnt(4)
    ds_write_b128 v120, v[144:147] offset:4096
    ds_write_b128 v120, v[148:151] offset:5120
    ds_write_b128 v120, v[152:155] offset:6144
    ds_write_b128 v120, v[156:159] offset:7168
    s_waitcnt lgkmcnt(4)
    ds_write_b128 v120, v[160:163] offset:8192
    ds_write_b128 v120, v[164:167] offset:9216
    ds_write_b128 v120, v[168:171] offset:10240
    ds_write_b128 v120, v[172:175] offset:11264
    s_waitcnt lgkmcnt(4)
    ds_write_b128 v120, v[176:179] offset:12288
    ds_write_b128 v120, v[180:183] offset:13312
    ds_write_b128 v120, v[184:187] offset:14336
    ds_write_b128 v120, v[188:191] offset:15360
    s_waitcnt lgkmcnt(4)
    ds_write_b128 v120, v[192:195] offset:16384
    ds_write_b128 v120, v[196:199] offset:17408
    ds_write_b128 v120, v[200:203] offset:18432
    ds_write_b128 v120, v[204:207] offset:19456
    s_waitcnt lgkmcnt(4)
    ds_write_b128 v120, v[208:211] offset:20480
    ds_write_b128 v120, v[212:215] offset:21504
    ds_write_b128 v120, v[216:219] offset:22528
    ds_write_b128 v120, v[220:223] offset:23552
    s_waitcnt lgkmcnt(4)
    ds_write_b128 v120, v[224:227] offset:24576
    ds_write_b128 v120, v[228:231] offset:25600
    ds_write_b128 v120, v[232:235] offset:26624
    ds_write_b128 v120, v[236:239] offset:27648
    s_waitcnt lgkmcnt(4)
    ds_write_b128 v120, v[240:243] offset:28672
    ds_write_b128 v120, v[244:247] offset:29696
    ds_write_b128 v120, v[248:251] offset:30720
    ds_write_b128 v120, v[252:255] offset:31744
    s_waitcnt lgkmcnt(4)
    ds_write_b32 v125, v19 offset:48

    s_endpgm

L_end:
    s_endpgm
.section .rodata,"a"
.p2align 6
.amdhsa_kernel gated_mix__linear_attn_block__linear_attn_block__prompt_kernel
  .amdhsa_next_free_vgpr 256
  .amdhsa_next_free_sgpr 102
  .amdhsa_accum_offset 256
  .amdhsa_group_segment_fixed_size 0
  .amdhsa_kernarg_size 80
  .amdhsa_user_sgpr_count 2
  .amdhsa_user_sgpr_kernarg_segment_ptr 1
  .amdhsa_system_sgpr_workgroup_id_x 1
.end_amdhsa_kernel
```
